```python
import torch

def _softmax(x, axis=-1):
    return torch.softmax(x, dim=axis)
def _gelu(x):
    return torch.nn.functional.gelu(x, approximate="tanh")
def _silu(x):
    return torch.nn.functional.silu(x)
def _sigmoid(x):
    return torch.sigmoid(x)
def _layernorm(x, axis=-1, eps=1e-5):
    m = x.mean(dim=axis, keepdim=True)
    v = x.var(dim=axis, keepdim=True, unbiased=False)
    return (x - m) / torch.sqrt(v + eps)
def _scatter_add(tgt, idx, src, axis=0):
    return tgt.clone().index_add_(axis, idx, src)
def _segment_sum(src, seg, n):
    out = torch.zeros((n,) + src.shape[1:], dtype=src.dtype)
    return out.index_add_(0, seg, src)
def _pad(x, pw):
    flat = tuple(v for pair in reversed(pw) for v in pair)
    return torch.nn.functional.pad(x, flat)

kernel_name = 'recurrent_scan__sliding_block_cached__swiglu_ffn__decode'

def setup_inputs():

    _w = (lambda a: (lambda t: t.to(torch.bfloat16) if t.is_floating_point() else t)(torch.as_tensor(a)))
    def _A_setup():
        B, Sq, D = 1, 1, 448
        Hq, Hkv, Sk, Dh = 16, 8, 65536, 256
        assert Hq % Hkv == 0, (Hq, Hkv)
        return {
            "x": _w((lambda *s: torch.randn(*s, dtype=torch.bfloat16) * 0.05)(B, Sq, D)),
            "k_cache": _w((lambda *s: torch.randn(*s, dtype=torch.bfloat16) * 1.6)(B, Hkv, Sk, Dh)),
            "v_cache": _w((lambda *s: torch.randn(*s, dtype=torch.bfloat16) * 0.2)(B, Hkv, Sk, Dh)),
            "wq": _w((lambda *s: torch.randn(*s, dtype=torch.bfloat16) * 1.6)(D, Hq * Dh) * (D ** -0.5)),
            "wo": _w((lambda *s: torch.randn(*s, dtype=torch.bfloat16) * 0.2)(Hq * Dh, D) * ((Hq * Dh) ** -0.5)),
        }
    _A_in = _A_setup()

    def _B_setup():
        B, S, D, F = 1, 1, 448, 1792
        return {
            "x": _w((lambda *s: torch.randn(*s, dtype=torch.bfloat16) * 0.05)(B, S, D)),
            "w_gate": _w((lambda *s: torch.randn(*s, dtype=torch.bfloat16) * 0.1)(D, F)),
            "w_up": _w((lambda *s: torch.randn(*s, dtype=torch.bfloat16) * 0.1)(D, F)),
            "w_down": _w((lambda *s: torch.randn(*s, dtype=torch.bfloat16) * 0.1)(F, D)),
        }
    _B_in = _B_setup()

    return {
        "A_x": _A_in["x"],
        "A_k_cache": _A_in["k_cache"],
        "A_v_cache": _A_in["v_cache"],
        "A_wq": _A_in["wq"],
        "A_wo": _A_in["wo"],
        "B_x": _B_in["x"],
        "B_w_gate": _B_in["w_gate"],
        "B_w_up": _B_in["w_up"],
        "B_w_down": _B_in["w_down"],
    }

def reference(A_x, A_k_cache, A_v_cache, A_wq, A_wo, B_x, B_w_gate, B_w_up, B_w_down):
    def _A_ref(x, k_cache, v_cache, wq, wo):
        B, Sq, D = x.shape
        Hq, Dh = 16, 256
        Hkv, Sk = k_cache.shape[1], k_cache.shape[2]
        W = min(4096, max(256, Sk // 4))
        rep = Hq // Hkv
        q = (lambda x, *d: x.permute(*d))((x @ wq).reshape(B, Sq, Hq, Dh), 0, 2, 1, 3)
        k = (lambda x, n, axis: torch.repeat_interleave(x, n, dim=axis))(k_cache[:, :, Sk - W:, :], rep, axis=1)
        v = (lambda x, n, axis: torch.repeat_interleave(x, n, dim=axis))(v_cache[:, :, Sk - W:, :], rep, axis=1)
        scores = torch.einsum("bhqd,bhkd->bhqk", q, k) * (Dh ** -0.5)
        p = _softmax(scores, axis=-1)
        o = torch.einsum("bhqk,bhkd->bhqd", p, v)
        return (lambda x, *d: x.permute(*d))(o, 0, 2, 1, 3).reshape(B, Sq, Hq * Dh) @ wo

    def _B_ref(x, w_gate, w_up, w_down):
        g = _silu(x @ w_gate)
        u = x @ w_up
        return (g * u) @ w_down

    x = A_x
    xn = _layernorm(x, axis=-1)
    s = _A_ref(xn, A_k_cache, A_v_cache, A_wq, A_wo)
    g = _silu(_B_ref(xn, B_w_gate, B_w_up, B_w_down))
    return x + s * g
```

```asm
; @launch grid=(256,1,1) block=(512,1,1) lds=8192
.amdgcn_target "amdgcn-amd-amdhsa--gfx950"
.text
.p2align 12
.globl recurrent_scan__sliding_block_cached__swiglu_ffn__decode_kernel
.p2align 8
.type recurrent_scan__sliding_block_cached__swiglu_ffn__decode_kernel,@function
recurrent_scan__sliding_block_cached__swiglu_ffn__decode_kernel:
s_cmp_ge_u32 s2, 256
s_cbranch_scc1 L_end
s_load_dwordx16 s[16:31], s[0:1], 0
s_load_dwordx8 s[32:39], s[0:1], 64
v_lshrrev_b32 v1, 6, v0
v_and_b32 v0, 63, v0
v_readfirstlane_b32 s3, v1
s_and_b32 s4, s2, 7
s_lshr_b32 s5, s2, 3
v_and_b32 v2, 15, v0
v_lshrrev_b32 v3, 4, v0
s_cmp_ge_u32 s3, 4
s_nop 0
s_cbranch_scc1 L_ve
s_memrealtime s[52:53]
s_cmp_eq_u32 s3, 1
s_cbranch_scc1 P5
s_cmp_eq_u32 s3, 2
s_cbranch_scc1 P6
s_cmp_eq_u32 s3, 3
s_cbranch_scc1 P7
s_branch L_k
L_ve:
s_setprio 3
s_memrealtime s[86:87]
s_sub_u32 s3, s3, 4
s_mov_b32 s42, 896
s_mov_b32 s43, 0x20000
s_mov_b32 s63, 0
s_cmp_eq_u32 s3, 1
s_cbranch_scc1 L_pro_q
s_cmp_eq_u32 s3, 2
s_cbranch_scc1 P1
s_cmp_eq_u32 s3, 3
s_cbranch_scc1 P2
s_cmp_gt_u32 s3, 1
s_cbranch_scc1 L_v_b0
s_cmp_gt_u32 s5, 27
s_cbranch_scc1 L_v_b0
s_mul_i32 s59, s4, 28
s_add_u32 s59, s59, s5
s_xor_b32 s63, s59, 0
s_lshr_b32 s63, s63, 3
s_movk_i32 s48, 3584
s_mov_b32 s46, 1605632
s_and_b32 s62, s59, 3
s_branch L_pro_c
L_pro_q:
s_and_b32 s62, s5, 3
s_lshl_b32 s63, s4, 3
s_lshr_b32 s45, s5, 2
s_xor_b32 s45, s45, 4
s_add_u32 s63, s63, s45
s_movk_i32 s48, 0x2000
s_mov_b32 s46, 3670016
s_mov_b32 s59, 0x80000000
L_pro_c:
s_mul_i32 s7, s62, 112
s_mul_i32 s44, s7, s48
s_lshl_b32 s45, s63, 7
s_add_u32 s44, s44, s45
s_sub_u32 s46, s46, s44
s_lshl_b32 s7, s7, 1
s_mul_i32 s45, s48, 14
v_and_b32 v14, 7, v0
v_lshrrev_b32 v15, 3, v0
v_mul_u32_u24 v5, s45, v15
v_lshl_add_u32 v5, v14, 4, v5
v_mul_u32_u24 v4, 28, v15
v_add_u32 v4, s7, v4
v_lshlrev_b32 v1, 4, v0
s_mov_b32 s62, s59
s_add_u32 s49, s48, s48
s_add_u32 s50, s49, s48
s_add_u32 s51, s50, s48
s_add_u32 s52, s51, s48
s_add_u32 s53, s52, s48
s_add_u32 s54, s53, s48
s_add_u32 s55, s54, s48
s_add_u32 s56, s55, s48
s_add_u32 s57, s56, s48
s_add_u32 s58, s57, s48
s_add_u32 s59, s58, s48
s_add_u32 s60, s59, s48
s_mov_b32 s47, 0x20000
s_mov_b32 s63, 1
s_bitcmp1_b32 s62, 2
s_waitcnt lgkmcnt(0)
s_cselect_b64 s[28:29], s[30:31], s[28:29]
s_cmp_lt_i32 s62, 0
s_cselect_b64 s[28:29], s[22:23], s[28:29]
s_mov_b32 s40, s16
s_mov_b32 s41, s17
s_add_u32 s44, s28, s44
s_addc_u32 s45, s29, 0
buffer_load_dwordx4 v[24:27], v1, s[40:43], 0 offen
buffer_load_dwordx4 v[16:19], v4, s[40:43], 0 offen
buffer_load_dwordx3 v[20:22], v4, s[40:43], 0 offen offset:16
s_cmp_lt_i32 s62, 0
s_cbranch_scc1 L_v_tl
s_load_dword s6, s[38:39], 0
s_barrier
s_sleep 15
L_v_tl:
buffer_load_dwordx4 v[64:67], v5, s[44:47], 0 offen nt
buffer_load_dwordx4 v[68:71], v5, s[44:47], s48 offen nt
buffer_load_dwordx4 v[72:75], v5, s[44:47], s49 offen nt
buffer_load_dwordx4 v[76:79], v5, s[44:47], s50 offen nt
buffer_load_dwordx4 v[80:83], v5, s[44:47], s51 offen nt
buffer_load_dwordx4 v[84:87], v5, s[44:47], s52 offen nt
buffer_load_dwordx4 v[88:91], v5, s[44:47], s53 offen nt
buffer_load_dwordx4 v[92:95], v5, s[44:47], s54 offen nt
buffer_load_dwordx4 v[96:99], v5, s[44:47], s55 offen nt
buffer_load_dwordx4 v[100:103], v5, s[44:47], s56 offen nt
buffer_load_dwordx4 v[104:107], v5, s[44:47], s57 offen nt
buffer_load_dwordx4 v[108:111], v5, s[44:47], s58 offen nt
buffer_load_dwordx4 v[112:115], v5, s[44:47], s59 offen nt
buffer_load_dwordx4 v[116:119], v5, s[44:47], s60 offen nt
s_cmp_ge_i32 s62, 0
s_cbranch_scc1 L_v
L_v_b0:
s_waitcnt lgkmcnt(0)
s_load_dword s6, s[38:39], 0
s_barrier
s_cmp_lg_u32 s3, 2
s_cbranch_scc1 L_v_npt
s_lshl_b32 s0, s4, 9
s_lshl_b32 s7, s5, 3
s_add_u32 s0, s0, s7
s_mul_i32 s0, s0, 896
s_mov_b64 exec, 3
v_mul_u32_u24 v29, 229376, v0
v_add_u32 v29, s0, v29
global_load_dword v42, v29, s[24:25] nt
s_mul_i32 s0, s4, 28
s_min_u32 s7, s5, 27
s_add_u32 s0, s0, s7
s_mul_i32 s0, s0, 7168
s_mov_b64 exec, 1
v_mov_b32 v30, s0
global_load_dword v41, v30, s[32:33] nt
s_lshl_b32 s0, s4, 5
s_add_u32 s0, s0, s5
s_lshl_b32 s0, s0, 12
s_add_u32 s0, s0, 1051648
s_mov_b64 exec, 3
v_lshlrev_b32 v31, 20, v0
v_add_u32 v31, s0, v31
global_load_dword v40, v31, s[38:39] nt
s_mov_b64 exec, -1
L_v_npt:
s_xor_b32 s7, s3, 3
s_or_b32 s7, s7, s5
s_cmp_eq_u32 s7, 0
s_cbranch_scc1 L_dec
s_cmp_eq_u32 s3, 2
s_cbranch_scc1 P3
s_cmp_eq_u32 s3, 3
s_cbranch_scc1 P8
L_v_r2:
L_v:
s_mov_b32 s8, s38
s_mov_b32 s9, s39
s_mov_b32 s10, 16777216
s_mov_b32 s11, 0x20000
s_mov_b32 s40, s16
s_mov_b32 s41, s17
s_lshl_b32 s0, s4, 25
s_add_u32 s0, s0, 0x1e00000
s_add_u32 s64, s20, s0
s_addc_u32 s65, s21, 0
s_mov_b32 s66, 2097152
s_mov_b32 s67, 0x20000
s_mov_b32 s68, 1048576
s_mov_b32 s69, 0
s_lshl_b32 s0, s4, 9
s_lshl_b32 s7, s5, 3
s_add_u32 s0, s0, s7
s_mul_i32 s0, s0, 896
s_add_u32 s52, s24, s0
s_addc_u32 s53, s25, 0
s_mul_i32 s0, s4, 28
s_min_u32 s7, s5, 27
s_add_u32 s0, s0, s7
s_mul_i32 s0, s0, 7168
s_add_u32 s54, s32, s0
s_addc_u32 s55, s33, 0
s_mov_b32 s32, s34
s_mov_b32 s33, s35
s_mov_b32 s34, 896
s_mov_b32 s35, 0x20000
s_getreg_b32 s17, hwreg(HW_REG_XCC_ID, 0, 3)
s_mov_b32 s16, 0x05040100
s_mov_b32 s18, 0x07060302
s_mov_b32 s19, 0x0c0c0400
s_mov_b32 s39, 0x04000c0c
s_mov_b32 s12, 0x07060500
s_mov_b32 s13, 0x07060501
s_mov_b32 s14, 0x07060502
s_mov_b32 s15, 0x07060503
v_mov_b32 v7, 3200
v_mov_b32 v8, 1
v_mov_b32 v11, 2147483632
s_cmp_eq_u32 s63, 0
s_nop 0
s_cbranch_scc1 L_v_nt
s_and_b32 s45, s62, 0xf8
s_lshl_b32 s45, s45, 8
s_and_b32 s46, s62, 7
s_lshl_b32 s46, s46, 5
s_add_u32 s45, s45, s46
s_add_u32 s45, s45, 131072
s_lshl_b32 s44, s4, 13
s_xor_b32 s46, s5, 16
s_lshl_b32 s46, s46, 8
s_add_u32 s44, s44, s46
s_add_u32 s44, s44, 524288
s_cmp_lt_i32 s62, 0
s_cselect_b32 s44, s44, s45
s_cselect_b32 s45, 5, 8
s_cselect_b32 s0, 0, 16777216
s_cselect_b32 s1, 65536, 0
v_lshrrev_b32 v13, 5, v0
v_lshlrev_b32 v13, 4, v13
v_lshlrev_b32 v10, s45, v14
v_add3_u32 v10, v10, v13, s44
v_and_b32 v13, 0x18, v0
v_cmp_eq_u32 vcc, 0, v13
s_nop 1
v_cndmask_b32 v10, v11, v10, vcc
s_waitcnt vmcnt(16)
v_lshlrev_b32 v32, 16, v24
v_and_b32 v33, 0xffff0000, v24
v_lshlrev_b32 v34, 16, v25
v_and_b32 v35, 0xffff0000, v25
v_lshlrev_b32 v36, 16, v26
v_and_b32 v37, 0xffff0000, v26
v_lshlrev_b32 v38, 16, v27
v_and_b32 v39, 0xffff0000, v27
v_pk_add_f32 v[46:47], v[32:33], v[34:35]
v_pk_add_f32 v[48:49], v[36:37], v[38:39]
v_pk_add_f32 v[46:47], v[46:47], v[48:49]
v_add_f32 v46, v46, v47
s_nop 1
v_add_f32_dpp v46, v46, v46 quad_perm:[1,0,3,2] row_mask:0xf bank_mask:0xf
s_nop 1
v_add_f32_dpp v46, v46, v46 quad_perm:[2,3,0,1] row_mask:0xf bank_mask:0xf
s_nop 1
v_add_f32_dpp v46, v46, v46 row_ror:4 row_mask:0xf bank_mask:0xf
s_nop 1
v_add_f32_dpp v46, v46, v46 row_ror:8 row_mask:0xf bank_mask:0xf
s_nop 1
v_add_f32_dpp v46, v46, v46 row_bcast:15 row_mask:0xa bank_mask:0xf
s_nop 1
v_add_f32_dpp v46, v46, v46 row_bcast:31 row_mask:0xc bank_mask:0xf
s_nop 0
v_readlane_b32 s48, v46, 63
v_mov_b32 v30, 0x3b124925
s_nop 0
v_mul_f32 v46, s48, v30
v_cmp_gt_u32 vcc, 56, v0
v_pk_add_f32 v[32:33], v[32:33], v[46:47] op_sel_hi:[1,0] neg_lo:[0,1] neg_hi:[0,1]
v_pk_add_f32 v[34:35], v[34:35], v[46:47] op_sel_hi:[1,0] neg_lo:[0,1] neg_hi:[0,1]
v_pk_add_f32 v[36:37], v[36:37], v[46:47] op_sel_hi:[1,0] neg_lo:[0,1] neg_hi:[0,1]
v_pk_add_f32 v[38:39], v[38:39], v[46:47] op_sel_hi:[1,0] neg_lo:[0,1] neg_hi:[0,1]
v_pk_mul_f32 v[24:25], v[32:33], v[32:33]
v_pk_fma_f32 v[24:25], v[34:35], v[34:35], v[24:25]
v_pk_fma_f32 v[24:25], v[36:37], v[36:37], v[24:25]
v_pk_fma_f32 v[24:25], v[38:39], v[38:39], v[24:25]
v_add_f32 v24, v24, v25
v_cndmask_b32 v24, 0, v24, vcc
s_nop 1
v_add_f32_dpp v24, v24, v24 quad_perm:[1,0,3,2] row_mask:0xf bank_mask:0xf
s_nop 1
v_add_f32_dpp v24, v24, v24 quad_perm:[2,3,0,1] row_mask:0xf bank_mask:0xf
s_nop 1
v_add_f32_dpp v24, v24, v24 row_ror:4 row_mask:0xf bank_mask:0xf
s_nop 1
v_add_f32_dpp v24, v24, v24 row_ror:8 row_mask:0xf bank_mask:0xf
s_nop 1
v_add_f32_dpp v24, v24, v24 row_bcast:15 row_mask:0xa bank_mask:0xf
s_nop 1
v_add_f32_dpp v24, v24, v24 row_bcast:31 row_mask:0xc bank_mask:0xf
s_nop 0
v_readlane_b32 s48, v24, 63
s_nop 1
v_mul_f32 v24, s48, v30
v_cvt_pk_bf16_f32 v25, v46, v24
v_lshlrev_b32 v46, 16, v25
v_and_b32 v24, 0xffff0000, v25
v_add_f32 v24, 0x3727c5ac, v24
v_cvt_pk_bf16_f32 v25, v24, v24
v_and_b32 v24, 0xffff0000, v25
v_sqrt_f32 v24, v24
s_nop 0
v_cvt_pk_bf16_f32 v25, v24, v24
v_and_b32 v24, 0xffff0000, v25
v_rcp_f32 v28, v24
s_waitcnt vmcnt(14)
v_lshlrev_b32 v32, 16, v16
v_and_b32 v33, 0xffff0000, v16
v_lshlrev_b32 v34, 16, v17
v_and_b32 v35, 0xffff0000, v17
v_lshlrev_b32 v36, 16, v18
v_and_b32 v37, 0xffff0000, v18
v_lshlrev_b32 v38, 16, v19
v_and_b32 v39, 0xffff0000, v19
v_lshlrev_b32 v40, 16, v20
v_and_b32 v41, 0xffff0000, v20
v_lshlrev_b32 v42, 16, v21
v_and_b32 v43, 0xffff0000, v21
v_lshlrev_b32 v44, 16, v22
v_and_b32 v45, 0xffff0000, v22
v_pk_add_f32 v[32:33], v[32:33], v[46:47] op_sel_hi:[1,0] neg_lo:[0,1] neg_hi:[0,1]
v_pk_add_f32 v[34:35], v[34:35], v[46:47] op_sel_hi:[1,0] neg_lo:[0,1] neg_hi:[0,1]
v_pk_add_f32 v[36:37], v[36:37], v[46:47] op_sel_hi:[1,0] neg_lo:[0,1] neg_hi:[0,1]
v_pk_add_f32 v[38:39], v[38:39], v[46:47] op_sel_hi:[1,0] neg_lo:[0,1] neg_hi:[0,1]
v_pk_add_f32 v[40:41], v[40:41], v[46:47] op_sel_hi:[1,0] neg_lo:[0,1] neg_hi:[0,1]
v_pk_add_f32 v[42:43], v[42:43], v[46:47] op_sel_hi:[1,0] neg_lo:[0,1] neg_hi:[0,1]
v_pk_add_f32 v[44:45], v[44:45], v[46:47] op_sel_hi:[1,0] neg_lo:[0,1] neg_hi:[0,1]
v_cvt_pk_bf16_f32 v16, v32, v33
v_cvt_pk_bf16_f32 v17, v34, v35
v_cvt_pk_bf16_f32 v18, v36, v37
v_cvt_pk_bf16_f32 v19, v38, v39
v_cvt_pk_bf16_f32 v20, v40, v41
v_cvt_pk_bf16_f32 v21, v42, v43
v_cvt_pk_bf16_f32 v22, v44, v45
v_lshlrev_b32 v32, 16, v16
v_and_b32 v33, 0xffff0000, v16
v_lshlrev_b32 v34, 16, v17
v_and_b32 v35, 0xffff0000, v17
v_lshlrev_b32 v36, 16, v18
v_and_b32 v37, 0xffff0000, v18
v_lshlrev_b32 v38, 16, v19
v_and_b32 v39, 0xffff0000, v19
v_lshlrev_b32 v40, 16, v20
v_and_b32 v41, 0xffff0000, v20
v_lshlrev_b32 v42, 16, v21
v_and_b32 v43, 0xffff0000, v21
v_lshlrev_b32 v44, 16, v22
v_and_b32 v45, 0xffff0000, v22
v_pk_mul_f32 v[46:47], v[32:33], v[28:29] op_sel_hi:[1,0]
v_pk_mul_f32 v[48:49], v[34:35], v[28:29] op_sel_hi:[1,0]
v_pk_mul_f32 v[50:51], v[36:37], v[28:29] op_sel_hi:[1,0]
v_pk_mul_f32 v[52:53], v[38:39], v[28:29] op_sel_hi:[1,0]
v_pk_mul_f32 v[54:55], v[40:41], v[28:29] op_sel_hi:[1,0]
v_pk_mul_f32 v[56:57], v[42:43], v[28:29] op_sel_hi:[1,0]
v_pk_mul_f32 v[58:59], v[44:45], v[28:29] op_sel_hi:[1,0]
v_pk_fma_f32 v[32:33], v[46:47], v[24:25], v[32:33] op_sel_hi:[1,0,1] neg_lo:[1,0,0] neg_hi:[1,0,0]
v_pk_fma_f32 v[34:35], v[48:49], v[24:25], v[34:35] op_sel_hi:[1,0,1] neg_lo:[1,0,0] neg_hi:[1,0,0]
v_pk_fma_f32 v[36:37], v[50:51], v[24:25], v[36:37] op_sel_hi:[1,0,1] neg_lo:[1,0,0] neg_hi:[1,0,0]
v_pk_fma_f32 v[38:39], v[52:53], v[24:25], v[38:39] op_sel_hi:[1,0,1] neg_lo:[1,0,0] neg_hi:[1,0,0]
v_pk_fma_f32 v[40:41], v[54:55], v[24:25], v[40:41] op_sel_hi:[1,0,1] neg_lo:[1,0,0] neg_hi:[1,0,0]
v_pk_fma_f32 v[42:43], v[56:57], v[24:25], v[42:43] op_sel_hi:[1,0,1] neg_lo:[1,0,0] neg_hi:[1,0,0]
v_pk_fma_f32 v[44:45], v[58:59], v[24:25], v[44:45] op_sel_hi:[1,0,1] neg_lo:[1,0,0] neg_hi:[1,0,0]
v_pk_fma_f32 v[46:47], v[32:33], v[28:29], v[46:47] op_sel_hi:[1,0,1]
v_pk_fma_f32 v[48:49], v[34:35], v[28:29], v[48:49] op_sel_hi:[1,0,1]
v_pk_fma_f32 v[50:51], v[36:37], v[28:29], v[50:51] op_sel_hi:[1,0,1]
v_pk_fma_f32 v[52:53], v[38:39], v[28:29], v[52:53] op_sel_hi:[1,0,1]
v_pk_fma_f32 v[54:55], v[40:41], v[28:29], v[54:55] op_sel_hi:[1,0,1]
v_pk_fma_f32 v[56:57], v[42:43], v[28:29], v[56:57] op_sel_hi:[1,0,1]
v_pk_fma_f32 v[58:59], v[44:45], v[28:29], v[58:59] op_sel_hi:[1,0,1]
v_cvt_pk_bf16_f32 v16, v46, v47
v_cvt_pk_bf16_f32 v17, v48, v49
v_cvt_pk_bf16_f32 v18, v50, v51
v_cvt_pk_bf16_f32 v19, v52, v53
v_cvt_pk_bf16_f32 v20, v54, v55
v_cvt_pk_bf16_f32 v21, v56, v57
v_cvt_pk_bf16_f32 v22, v58, v59
s_waitcnt lgkmcnt(0)
s_mul_i32 s6, s6, 1664525
s_add_u32 s6, s6, 1013904223
s_or_b32 s6, s6, 1
v_mov_b32 v12, s6
s_nop 1
s_branch P1_o
P1:
s_branch L_v_b0
P1_o:
s_lshl_b32 s17, s17, 29
s_and_b32 s7, s6, 0x1fffffff
s_or_b32 s17, s17, s7
s_cmp_lt_i32 s62, 0
s_cselect_b32 s7, s17, s6
v_mov_b32 v124, s7
v_mov_b32 v32, 0
v_mov_b32 v33, 0
v_mov_b32 v34, 0
v_mov_b32 v35, 0
v_mov_b32 v36, 0
v_mov_b32 v37, 0
v_mov_b32 v38, 0
v_mov_b32 v39, 0
s_waitcnt vmcnt(12)
v_perm_b32 v40, v68, v64, s16
v_perm_b32 v41, v68, v64, s18
v_perm_b32 v42, v69, v65, s16
v_perm_b32 v43, v69, v65, s18
v_perm_b32 v44, v70, v66, s16
v_perm_b32 v45, v70, v66, s18
v_perm_b32 v46, v71, v67, s16
v_perm_b32 v47, v71, v67, s18
v_dot2c_f32_bf16 v32, v40, v16
v_dot2c_f32_bf16 v33, v41, v16
v_dot2c_f32_bf16 v34, v42, v16
v_dot2c_f32_bf16 v35, v43, v16
v_dot2c_f32_bf16 v36, v44, v16
v_dot2c_f32_bf16 v37, v45, v16
v_dot2c_f32_bf16 v38, v46, v16
v_dot2c_f32_bf16 v39, v47, v16
s_waitcnt vmcnt(10)
v_perm_b32 v40, v76, v72, s16
v_perm_b32 v41, v76, v72, s18
v_perm_b32 v42, v77, v73, s16
v_perm_b32 v43, v77, v73, s18
v_perm_b32 v44, v78, v74, s16
v_perm_b32 v45, v78, v74, s18
v_perm_b32 v46, v79, v75, s16
v_perm_b32 v47, v79, v75, s18
v_dot2c_f32_bf16 v32, v40, v17
v_dot2c_f32_bf16 v33, v41, v17
v_dot2c_f32_bf16 v34, v42, v17
v_dot2c_f32_bf16 v35, v43, v17
v_dot2c_f32_bf16 v36, v44, v17
v_dot2c_f32_bf16 v37, v45, v17
v_dot2c_f32_bf16 v38, v46, v17
v_dot2c_f32_bf16 v39, v47, v17
s_waitcnt vmcnt(8)
v_perm_b32 v40, v84, v80, s16
v_perm_b32 v41, v84, v80, s18
v_perm_b32 v42, v85, v81, s16
v_perm_b32 v43, v85, v81, s18
v_perm_b32 v44, v86, v82, s16
v_perm_b32 v45, v86, v82, s18
v_perm_b32 v46, v87, v83, s16
v_perm_b32 v47, v87, v83, s18
v_dot2c_f32_bf16 v32, v40, v18
v_dot2c_f32_bf16 v33, v41, v18
v_dot2c_f32_bf16 v34, v42, v18
v_dot2c_f32_bf16 v35, v43, v18
v_dot2c_f32_bf16 v36, v44, v18
v_dot2c_f32_bf16 v37, v45, v18
v_dot2c_f32_bf16 v38, v46, v18
v_dot2c_f32_bf16 v39, v47, v18
s_waitcnt vmcnt(6)
v_perm_b32 v40, v92, v88, s16
v_perm_b32 v41, v92, v88, s18
v_perm_b32 v42, v93, v89, s16
v_perm_b32 v43, v93, v89, s18
v_perm_b32 v44, v94, v90, s16
v_perm_b32 v45, v94, v90, s18
v_perm_b32 v46, v95, v91, s16
v_perm_b32 v47, v95, v91, s18
v_dot2c_f32_bf16 v32, v40, v19
v_dot2c_f32_bf16 v33, v41, v19
v_dot2c_f32_bf16 v34, v42, v19
v_dot2c_f32_bf16 v35, v43, v19
v_dot2c_f32_bf16 v36, v44, v19
v_dot2c_f32_bf16 v37, v45, v19
v_dot2c_f32_bf16 v38, v46, v19
v_dot2c_f32_bf16 v39, v47, v19
s_waitcnt vmcnt(4)
v_perm_b32 v40, v100, v96, s16
v_perm_b32 v41, v100, v96, s18
v_perm_b32 v42, v101, v97, s16
v_perm_b32 v43, v101, v97, s18
v_perm_b32 v44, v102, v98, s16
v_perm_b32 v45, v102, v98, s18
v_perm_b32 v46, v103, v99, s16
v_perm_b32 v47, v103, v99, s18
v_dot2c_f32_bf16 v32, v40, v20
v_dot2c_f32_bf16 v33, v41, v20
v_dot2c_f32_bf16 v34, v42, v20
v_dot2c_f32_bf16 v35, v43, v20
v_dot2c_f32_bf16 v36, v44, v20
v_dot2c_f32_bf16 v37, v45, v20
v_dot2c_f32_bf16 v38, v46, v20
v_dot2c_f32_bf16 v39, v47, v20
s_waitcnt vmcnt(2)
v_perm_b32 v40, v108, v104, s16
v_perm_b32 v41, v108, v104, s18
v_perm_b32 v42, v109, v105, s16
v_perm_b32 v43, v109, v105, s18
v_perm_b32 v44, v110, v106, s16
v_perm_b32 v45, v110, v106, s18
v_perm_b32 v46, v111, v107, s16
v_perm_b32 v47, v111, v107, s18
v_dot2c_f32_bf16 v32, v40, v21
v_dot2c_f32_bf16 v33, v41, v21
v_dot2c_f32_bf16 v34, v42, v21
v_dot2c_f32_bf16 v35, v43, v21
v_dot2c_f32_bf16 v36, v44, v21
v_dot2c_f32_bf16 v37, v45, v21
v_dot2c_f32_bf16 v38, v46, v21
v_dot2c_f32_bf16 v39, v47, v21
s_waitcnt vmcnt(0)
v_perm_b32 v40, v116, v112, s16
v_perm_b32 v41, v116, v112, s18
v_perm_b32 v42, v117, v113, s16
v_perm_b32 v43, v117, v113, s18
v_perm_b32 v44, v118, v114, s16
v_perm_b32 v45, v118, v114, s18
v_perm_b32 v46, v119, v115, s16
v_perm_b32 v47, v119, v115, s18
v_dot2c_f32_bf16 v32, v40, v22
v_dot2c_f32_bf16 v33, v41, v22
v_dot2c_f32_bf16 v34, v42, v22
v_dot2c_f32_bf16 v35, v43, v22
v_dot2c_f32_bf16 v36, v44, v22
v_dot2c_f32_bf16 v37, v45, v22
v_dot2c_f32_bf16 v38, v46, v22
v_dot2c_f32_bf16 v39, v47, v22
v_permlane32_swap_b32 v32, v36
v_permlane32_swap_b32 v33, v37
v_permlane32_swap_b32 v34, v38
v_permlane32_swap_b32 v35, v39
v_pk_add_f32 v[32:33], v[32:33], v[36:37]
v_pk_add_f32 v[34:35], v[34:35], v[38:39]
s_nop 0
v_add_f32_dpp v32, v32, v32 row_ror:8 row_mask:0xf bank_mask:0xf
v_add_f32_dpp v33, v33, v33 row_ror:8 row_mask:0xf bank_mask:0xf
v_add_f32_dpp v34, v34, v34 row_ror:8 row_mask:0xf bank_mask:0xf
v_add_f32_dpp v35, v35, v35 row_ror:8 row_mask:0xf bank_mask:0xf
v_mov_b32 v36, v32
v_mov_b32 v37, v33
v_mov_b32 v38, v34
v_mov_b32 v39, v35
v_permlane16_swap_b32 v32, v36
v_permlane16_swap_b32 v33, v37
v_permlane16_swap_b32 v34, v38
v_permlane16_swap_b32 v35, v39
v_pk_add_f32 v[32:33], v[32:33], v[36:37]
v_pk_add_f32 v[34:35], v[34:35], v[38:39]
v_perm_b32 v32, v32, v124, s12
v_perm_b32 v33, v33, v124, s13
v_perm_b32 v34, v34, v124, s14
v_perm_b32 v35, v35, v124, s15
buffer_store_dwordx4 v[32:35], v10, s[8:11], s0 offen
buffer_store_dwordx4 v[32:35], v10, s[8:11], s1 offen sc1
s_nop 1
s_branch L_v_t
L_v_nt:
s_waitcnt lgkmcnt(0)
s_mul_i32 s6, s6, 1664525
s_add_u32 s6, s6, 1013904223
s_or_b32 s6, s6, 1
v_mov_b32 v12, s6
s_nop 1
L_v_t:
v_lshrrev_b32 v5, 3, v2
v_and_b32 v14, 7, v2
v_lshlrev_b32 v6, 4, v14
v_lshl_add_u32 v6, v5, 11, v6
v_lshl_add_u32 v6, v3, 9, v6
s_lshl_b32 s7, s3, 7
s_lshl_b32 s0, s5, 12
s_add_u32 s7, s7, s0
v_add_u32 v6, s7, v6
s_mov_b32 s68, 0
s_mov_b32 s59, 131072
v_xor_b32 v5, 0x2000, v6
s_lshl_b32 s7, s2, 4
v_and_b32 v9, 1, v0
v_lshlrev_b32 v9, 3, v9
v_lshl_add_u32 v9, v3, 1, v9
v_add_u32 v9, s7, v9
buffer_load_ushort v126, v9, s[40:43], 0 offen
s_lshl_b32 s7, s4, 5
s_lshl_b32 s0, s3, 3
s_add_u32 s7, s7, s0
s_lshl_b32 s7, s7, 12
s_mul_i32 s0, s5, 64
s_add_u32 s7, s7, s0
s_add_u32 s7, s7, 1048576
s_mov_b32 s80, 0
s_mov_b32 s81, -1
s_mov_b32 s82, 0xff00ff00
s_mov_b32 s83, 0xff00ff00
s_mov_b32 s84, 0xff000000
s_mov_b32 s85, 0xff00ff00
s_mul_i32 s0, s5, -48
s_add_u32 s0, s0, 2048
v_lshrrev_b32 v16, 1, v3
v_and_b32 v17, 1, v3
v_lshlrev_b32 v121, 5, v17
v_lshl_add_u32 v121, v16, 4, v121
v_mov_b32 v17, s0
v_cndmask_b32 v121, v121, v17, s[82:83]
v_lshl_add_u32 v121, v14, 12, v121
v_add_u32 v121, s7, v121
v_cndmask_b32 v121, v121, v11, s[84:85]
v_cmp_gt_u32 vcc, 2, v2
s_nop 1
v_cndmask_b32 v9, v11, v9, vcc
s_mul_i32 s7, s2, 16384
s_add_u32 s7, s7, 2097152
v_lshlrev_b32 v122, 4, v0
v_add_u32 v122, s7, v122
s_lshl_b32 s0, s3, 1
s_add_u32 s0, s0, s4
s_add_u32 s7, s0, 0
s_and_b32 s7, s7, 7
s_lshl_b32 s48, s7, 11
s_add_u32 s49, s48, 1024
s_add_u32 s7, s0, 1
s_and_b32 s7, s7, 7
s_lshl_b32 s50, s7, 11
s_add_u32 s51, s50, 1024
s_lshl_b32 s87, s6, 2
v_lshlrev_b32 v120, 4, v0
v_add_u32 v120, 4096, v120
v_and_b32 v18, 3, v0
v_lshl_add_u32 v18, v3, 2, v18
v_lshlrev_b32 v18, 4, v18
v_add_u32 v18, 7168, v18
s_lshl_b32 s7, s3, 2
v_add_u32 v19, s7, v18
s_mov_b32 s22, 0x000f000f
s_mov_b32 s23, 0x000f000f
s_lshl_b32 s7, s4, 5
s_add_u32 s7, s7, s5
s_lshl_b32 s7, s7, 12
s_add_u32 s7, s7, 1048576
v_lshlrev_b32 v20, 4, v0
v_add_u32 v20, s7, v20
v_and_b32 v14, 1, v0
v_lshrrev_b32 v21, 2, v0
v_lshlrev_b32 v21, 5, v21
v_lshl_add_u32 v21, v14, 4, v21
v_add_u32 v21, s7, v21
s_mul_i32 s24, s6, 3
s_mov_b32 s28, 0xcccccccc
s_mov_b32 s29, 0xcccccccc
s_lshl_b32 s7, s3, 8
v_lshlrev_b32 v28, 4, v2
v_add_u32 v28, s7, v28
v_mul_u32_u24 v29, 896, v3
v_add_u32 v24, v28, v29
v_add_u32 v25, v24, v29
s_add_u32 s56, s52, 229376
s_addc_u32 s57, s53, 0
s_lshl_b32 s7, s3, 4
v_add_u32 v29, s7, v2
v_and_b32 v28, 1, v3
s_lshl_b32 s7, s4, 5
s_add_u32 s7, s7, s5
s_lshl_b32 s7, s7, 6
s_add_u32 s7, s7, 2097152
v_lshlrev_b32 v26, 5, v28
v_lshl_add_u32 v26, v16, 4, v26
v_lshl_add_u32 v26, v29, 14, v26
v_add_u32 v26, s7, v26
v_cmp_gt_u32 vcc, 56, v29
s_nop 1
v_cndmask_b32 v26, v11, v26, vcc
v_and_b32 v29, 7, v29
v_cmp_eq_u32 vcc, s4, v29
s_nop 1
v_cndmask_b32 v23, v11, v26, vcc
v_cndmask_b32 v27, v26, v11, vcc
v_lshlrev_b32 v15, 3, v3
v_add_u32 v15, 3072, v15
s_cmp_eq_u32 s3, 3
s_cselect_b32 s44, 0x00ff00ff, -1
s_mov_b32 s45, s44
s_mov_b32 s46, 0xf0f0f0f0
s_mov_b32 s47, s46
s_mov_b32 s40, 0x0f0f0f0f
s_mov_b32 s41, s40
s_mov_b32 s42, 0x00010001
s_mov_b32 s43, s42
v_mov_b32 v28, 0
v_mov_b32 v29, 0
v_mov_b32 v30, 0
v_mov_b32 v31, 0
s_nop 1
s_branch P2_o
.p2align 12
P2:
s_branch L_v_b0
P2_o:
s_branch L_v_wki_e
L_v_wki:
s_sleep 1
L_v_wki_e:
ds_read_b32 v13, v7 offset:28
s_add_u32 s69, s69, 1
s_waitcnt lgkmcnt(0)
v_readfirstlane_b32 s7, v13
s_cmp_gt_u32 s69, 262144
s_nop 3
s_cbranch_scc1 L_end
s_cmp_lt_u32 s7, 4
s_cbranch_scc1 L_v_wki
s_add_u32 s61, s86, 345
L_vp0:
s_memrealtime s[62:63]
s_waitcnt lgkmcnt(0)
s_sub_u32 s62, s62, s61
s_cmp_lt_i32 s62, 0
s_cbranch_scc1 L_vp0
buffer_load_dwordx4 v[128:131], v6, s[64:67], s68 offen nt
s_add_u32 s61, s61, 15
L_vp1:
s_memrealtime s[62:63]
s_waitcnt lgkmcnt(0)
s_sub_u32 s62, s62, s61
s_cmp_lt_i32 s62, 0
s_cbranch_scc1 L_vp1
s_add_u32 s68, s68, s59
buffer_load_dwordx4 v[132:135], v5, s[64:67], s68 offen nt
s_add_u32 s61, s61, 15
L_vp2:
s_memrealtime s[62:63]
s_waitcnt lgkmcnt(0)
s_sub_u32 s62, s62, s61
s_cmp_lt_i32 s62, 0
s_cbranch_scc1 L_vp2
s_add_u32 s68, s68, s59
buffer_load_dwordx4 v[136:139], v6, s[64:67], s68 offen nt
s_add_u32 s61, s61, 15
L_vp3:
s_memrealtime s[62:63]
s_waitcnt lgkmcnt(0)
s_sub_u32 s62, s62, s61
s_cmp_lt_i32 s62, 0
s_cbranch_scc1 L_vp3
s_add_u32 s68, s68, s59
buffer_load_dwordx4 v[140:143], v5, s[64:67], s68 offen nt
s_add_u32 s61, s61, 15
L_vp4:
s_memrealtime s[62:63]
s_waitcnt lgkmcnt(0)
s_sub_u32 s62, s62, s61
s_cmp_lt_i32 s62, 0
s_cbranch_scc1 L_vp4
s_add_u32 s68, s68, s59
buffer_load_dwordx4 v[144:147], v5, s[64:67], s68 offen nt
s_add_u32 s61, s61, 15
L_vp5:
s_memrealtime s[62:63]
s_waitcnt lgkmcnt(0)
s_sub_u32 s62, s62, s61
s_cmp_lt_i32 s62, 0
s_cbranch_scc1 L_vp5
s_add_u32 s68, s68, s59
buffer_load_dwordx4 v[148:151], v6, s[64:67], s68 offen nt
s_add_u32 s61, s61, 15
L_vp6:
s_memrealtime s[62:63]
s_waitcnt lgkmcnt(0)
s_sub_u32 s62, s62, s61
s_cmp_lt_i32 s62, 0
s_cbranch_scc1 L_vp6
s_add_u32 s68, s68, s59
buffer_load_dwordx4 v[152:155], v5, s[64:67], s68 offen nt
s_add_u32 s61, s61, 15
L_vp7:
s_memrealtime s[62:63]
s_waitcnt lgkmcnt(0)
s_sub_u32 s62, s62, s61
s_cmp_lt_i32 s62, 0
s_cbranch_scc1 L_vp7
s_add_u32 s68, s68, s59
buffer_load_dwordx4 v[156:159], v6, s[64:67], s68 offen nt
s_add_u32 s61, s61, 15
L_vp8:
s_memrealtime s[62:63]
s_waitcnt lgkmcnt(0)
s_sub_u32 s62, s62, s61
s_cmp_lt_i32 s62, 0
s_cbranch_scc1 L_vp8
s_add_u32 s68, s68, s59
buffer_load_dwordx4 v[160:163], v6, s[64:67], s68 offen nt
s_add_u32 s61, s61, 15
L_vp9:
s_memrealtime s[62:63]
s_waitcnt lgkmcnt(0)
s_sub_u32 s62, s62, s61
s_cmp_lt_i32 s62, 0
s_cbranch_scc1 L_vp9
s_add_u32 s68, s68, s59
buffer_load_dwordx4 v[164:167], v5, s[64:67], s68 offen nt
s_add_u32 s61, s61, 15
L_vp10:
s_memrealtime s[62:63]
s_waitcnt lgkmcnt(0)
s_sub_u32 s62, s62, s61
s_cmp_lt_i32 s62, 0
s_cbranch_scc1 L_vp10
s_add_u32 s68, s68, s59
buffer_load_dwordx4 v[168:171], v6, s[64:67], s68 offen nt
s_add_u32 s61, s61, 15
L_vp11:
s_memrealtime s[62:63]
s_waitcnt lgkmcnt(0)
s_sub_u32 s62, s62, s61
s_cmp_lt_i32 s62, 0
s_cbranch_scc1 L_vp11
s_add_u32 s68, s68, s59
buffer_load_dwordx4 v[172:175], v5, s[64:67], s68 offen nt
s_add_u32 s61, s61, 15
L_vp12:
s_memrealtime s[62:63]
s_waitcnt lgkmcnt(0)
s_sub_u32 s62, s62, s61
s_cmp_lt_i32 s62, 0
s_cbranch_scc1 L_vp12
s_add_u32 s68, s68, s59
buffer_load_dwordx4 v[176:179], v5, s[64:67], s68 offen nt
s_add_u32 s61, s61, 15
L_vp13:
s_memrealtime s[62:63]
s_waitcnt lgkmcnt(0)
s_sub_u32 s62, s62, s61
s_cmp_lt_i32 s62, 0
s_cbranch_scc1 L_vp13
s_add_u32 s68, s68, s59
buffer_load_dwordx4 v[180:183], v6, s[64:67], s68 offen nt
s_add_u32 s61, s61, 15
L_vp14:
s_memrealtime s[62:63]
s_waitcnt lgkmcnt(0)
s_sub_u32 s62, s62, s61
s_cmp_lt_i32 s62, 0
s_cbranch_scc1 L_vp14
s_add_u32 s68, s68, s59
buffer_load_dwordx4 v[184:187], v5, s[64:67], s68 offen nt
s_add_u32 s61, s61, 15
L_vp15:
s_memrealtime s[62:63]
s_waitcnt lgkmcnt(0)
s_sub_u32 s62, s62, s61
s_cmp_lt_i32 s62, 0
s_cbranch_scc1 L_vp15
s_add_u32 s68, s68, s59
buffer_load_dwordx4 v[188:191], v6, s[64:67], s68 offen nt
s_mov_b64 exec, 1
ds_add_u32 v7, v8 offset:24
s_mov_b64 exec, -1
s_add_u32 s61, s61, 18
L_v_wt:
s_memrealtime s[62:63]
s_waitcnt lgkmcnt(0)
s_sub_u32 s62, s62, s61
s_cmp_lt_i32 s62, 0
s_cbranch_scc1 L_v_wt
s_mov_b64 exec, s[44:45]
global_load_dwordx4 v[192:195], v24, s[52:53] offset:0 nt
global_load_dwordx4 v[196:199], v24, s[52:53] offset:3584 nt
global_load_dwordx4 v[200:203], v24, s[56:57] offset:0 nt
global_load_dwordx4 v[204:207], v24, s[56:57] offset:3584 nt
global_load_dwordx4 v[208:211], v25, s[54:55] offset:0 nt
global_load_dwordx4 v[212:215], v25, s[54:55] offset:896 nt
s_mov_b64 exec, -1
s_setprio 2
s_waitcnt vmcnt(20)
v_perm_b32 v64, v132, v128, s16
v_perm_b32 v68, v132, v128, s18
v_perm_b32 v72, v133, v129, s16
v_perm_b32 v76, v133, v129, s18
v_perm_b32 v80, v134, v130, s16
v_perm_b32 v84, v134, v130, s18
v_perm_b32 v88, v135, v131, s16
v_perm_b32 v92, v135, v131, s18
s_waitcnt vmcnt(18)
v_perm_b32 v65, v140, v136, s16
v_perm_b32 v69, v140, v136, s18
v_perm_b32 v73, v141, v137, s16
v_perm_b32 v77, v141, v137, s18
v_perm_b32 v81, v142, v138, s16
v_perm_b32 v85, v142, v138, s18
v_perm_b32 v89, v143, v139, s16
v_perm_b32 v93, v143, v139, s18
s_waitcnt vmcnt(16)
v_perm_b32 v66, v148, v144, s16
v_perm_b32 v70, v148, v144, s18
v_perm_b32 v74, v149, v145, s16
v_perm_b32 v78, v149, v145, s18
v_perm_b32 v82, v150, v146, s16
v_perm_b32 v86, v150, v146, s18
v_perm_b32 v90, v151, v147, s16
v_perm_b32 v94, v151, v147, s18
s_waitcnt vmcnt(14)
v_perm_b32 v67, v156, v152, s16
v_perm_b32 v71, v156, v152, s18
v_perm_b32 v75, v157, v153, s16
v_perm_b32 v79, v157, v153, s18
v_perm_b32 v83, v158, v154, s16
v_perm_b32 v87, v158, v154, s18
v_perm_b32 v91, v159, v155, s16
v_perm_b32 v95, v159, v155, s18
s_nop 1
s_branch P3_o
P3:
s_branch P4
P3_o:
L_v_wp:
ds_read_b32 v13, v7 offset:36
ds_read_b32 v14, v7 offset:4
ds_read_b128 v[100:103], v120 offset:0
ds_read_b128 v[104:107], v120 offset:1024
ds_read_b128 v[108:111], v120 offset:2048
s_add_u32 s69, s69, 1
s_waitcnt lgkmcnt(0)
v_readfirstlane_b32 s7, v13
s_cmp_gt_u32 s69, 262144
s_nop 3
s_cbranch_scc1 L_end
s_cmp_eq_u32 s7, 0
s_cbranch_scc1 L_v_wp
v_readfirstlane_b32 s61, v14
v_mfma_f32_16x16x32_bf16 v[32:35], v[100:103], v[64:67], 0
v_mfma_f32_16x16x32_bf16 v[36:39], v[100:103], v[68:71], 0
v_mfma_f32_16x16x32_bf16 v[40:43], v[100:103], v[72:75], 0
v_mfma_f32_16x16x32_bf16 v[44:47], v[100:103], v[76:79], 0
v_mfma_f32_16x16x32_bf16 v[48:51], v[100:103], v[80:83], 0
v_mfma_f32_16x16x32_bf16 v[52:55], v[100:103], v[84:87], 0
v_mfma_f32_16x16x32_bf16 v[56:59], v[100:103], v[88:91], 0
v_mfma_f32_16x16x32_bf16 v[60:63], v[100:103], v[92:95], 0
s_waitcnt vmcnt(12)
v_perm_b32 v64, v164, v160, s16
v_perm_b32 v68, v164, v160, s18
v_perm_b32 v72, v165, v161, s16
v_perm_b32 v76, v165, v161, s18
v_perm_b32 v80, v166, v162, s16
v_perm_b32 v84, v166, v162, s18
v_perm_b32 v88, v167, v163, s16
v_perm_b32 v92, v167, v163, s18
s_waitcnt vmcnt(10)
v_perm_b32 v65, v172, v168, s16
v_perm_b32 v69, v172, v168, s18
v_perm_b32 v73, v173, v169, s16
v_perm_b32 v77, v173, v169, s18
v_perm_b32 v81, v174, v170, s16
v_perm_b32 v85, v174, v170, s18
v_perm_b32 v89, v175, v171, s16
v_perm_b32 v93, v175, v171, s18
s_waitcnt vmcnt(8)
v_perm_b32 v66, v180, v176, s16
v_perm_b32 v70, v180, v176, s18
v_perm_b32 v74, v181, v177, s16
v_perm_b32 v78, v181, v177, s18
v_perm_b32 v82, v182, v178, s16
v_perm_b32 v86, v182, v178, s18
v_perm_b32 v90, v183, v179, s16
v_perm_b32 v94, v183, v179, s18
s_waitcnt vmcnt(6)
v_perm_b32 v67, v188, v184, s16
v_perm_b32 v71, v188, v184, s18
v_perm_b32 v75, v189, v185, s16
v_perm_b32 v79, v189, v185, s18
v_perm_b32 v83, v190, v186, s16
v_perm_b32 v87, v190, v186, s18
v_perm_b32 v91, v191, v187, s16
v_perm_b32 v95, v191, v187, s18
v_mfma_f32_16x16x32_bf16 v[32:35], v[104:107], v[64:67], v[32:35]
v_mfma_f32_16x16x32_bf16 v[36:39], v[104:107], v[68:71], v[36:39]
v_mfma_f32_16x16x32_bf16 v[40:43], v[104:107], v[72:75], v[40:43]
v_mfma_f32_16x16x32_bf16 v[44:47], v[104:107], v[76:79], v[44:47]
v_mfma_f32_16x16x32_bf16 v[48:51], v[104:107], v[80:83], v[48:51]
v_mfma_f32_16x16x32_bf16 v[52:55], v[104:107], v[84:87], v[52:55]
v_mfma_f32_16x16x32_bf16 v[56:59], v[104:107], v[88:91], v[56:59]
v_mfma_f32_16x16x32_bf16 v[60:63], v[104:107], v[92:95], v[60:63]
s_nop 0
v_add_f32_dpp v112, v33, v32 row_shl:8 row_mask:0xf bank_mask:0xf bound_ctrl:0
v_add_f32_dpp v113, v37, v36 row_shl:8 row_mask:0xf bank_mask:0xf bound_ctrl:0
v_add_f32_dpp v114, v41, v40 row_shl:8 row_mask:0xf bank_mask:0xf bound_ctrl:0
v_add_f32_dpp v115, v45, v44 row_shl:8 row_mask:0xf bank_mask:0xf bound_ctrl:0
v_add_f32_dpp v116, v49, v48 row_shl:8 row_mask:0xf bank_mask:0xf bound_ctrl:0
v_add_f32_dpp v117, v53, v52 row_shl:8 row_mask:0xf bank_mask:0xf bound_ctrl:0
v_add_f32_dpp v118, v57, v56 row_shl:8 row_mask:0xf bank_mask:0xf bound_ctrl:0
v_add_f32_dpp v119, v61, v60 row_shl:8 row_mask:0xf bank_mask:0xf bound_ctrl:0
v_cndmask_b32 v112, v112, v116, s[80:81]
v_cndmask_b32 v113, v113, v117, s[80:81]
v_cndmask_b32 v114, v114, v118, s[80:81]
v_cndmask_b32 v115, v115, v119, s[80:81]
v_cndmask_b32 v112, v112, v108, s[82:83]
v_cndmask_b32 v113, v113, v109, s[82:83]
v_cndmask_b32 v114, v114, v110, s[82:83]
v_cndmask_b32 v115, v115, v111, s[82:83]
v_perm_b32 v112, v112, v12, s12
v_perm_b32 v113, v113, v12, s13
v_perm_b32 v114, v114, v12, s14
v_perm_b32 v115, v115, v12, s15
s_cmp_lg_u32 s61, 4
s_nop 0
s_cbranch_scc1 L_v_st1
buffer_store_dwordx4 v[112:115], v121, s[8:11], 0 offen
s_nop 1
s_branch L_v_st2
L_v_st1:
s_mov_b32 s7, 2097152
buffer_store_dwordx4 v[112:115], v121, s[8:11], s7 offen sc1
s_nop 1
L_v_st2:
s_mov_b64 exec, 1
ds_add_u32 v7, v8 offset:20
s_mov_b64 exec, -1
s_cmp_eq_u32 s61, 4
s_cselect_b32 s31, 0, 2097152
L_v_wst:
ds_read2_b32 v[16:17], v7 offset0:5 offset1:13
s_add_u32 s69, s69, 1
s_waitcnt lgkmcnt(0)
v_readfirstlane_b32 s7, v16
v_readfirstlane_b32 s58, v17
s_cmp_gt_u32 s69, 262144
s_nop 3
s_cbranch_scc1 L_end
s_cmp_eq_u32 s58, 0
s_cselect_b32 s7, 0, s7
s_cmp_lt_u32 s7, 4
s_cbranch_scc1 L_v_wst
s_branch P4_o
P4:
s_branch L_v_r2
L_v_p1r:
s_mov_b64 exec, s[26:27]
buffer_load_dwordx4 v[128:131], v20, s[8:11], s31 offen sc1
buffer_load_dwordx4 v[132:135], v20, s[8:11], s31 offen offset:1024 sc1
buffer_load_dwordx4 v[136:139], v21, s[8:11], s31 offen offset:2048 sc1
s_mov_b64 exec, s[40:41]
L_v_p1c:
ds_read_b32 v13, v7 offset:8
ds_read_b64 v[28:29], v15
s_mov_b64 exec, -1
s_add_u32 s69, s69, 1
s_waitcnt lgkmcnt(0)
v_readfirstlane_b32 s7, v13
s_nop 0
s_cmp_lg_u32 s7, 0
s_nop 2
s_cbranch_scc1 L_v_h1done
s_cmp_gt_u32 s69, 262144
s_cbranch_scc1 L_end
s_branch L_v_p1d
P4_o:
s_add_u32 s60, s86, 680
L_v_h1t:
s_memrealtime s[62:63]
s_waitcnt lgkmcnt(0)
s_sub_u32 s62, s62, s60
s_cmp_lt_i32 s62, 0
s_cbranch_scc1 L_v_h1t
s_mov_b32 s7, s3
L_v_stg:
s_cmp_eq_u32 s7, 0
s_cbranch_scc1 L_v_p1
s_sleep 1
s_sub_u32 s7, s7, 1
s_branch L_v_stg
L_v_p1:
buffer_load_dwordx4 v[128:131], v20, s[8:11], s31 offen sc1
buffer_load_dwordx4 v[132:135], v20, s[8:11], s31 offen offset:1024 sc1
buffer_load_dwordx4 v[136:139], v21, s[8:11], s31 offen offset:2048 sc1
s_and_b32 s58, s58, 0x2000
v_xor_b32 v23, s58, v23
v_xor_b32 v26, s58, v26
v_xor_b32 v27, s58, v27
v_mov_b32 v67, 0
v_mov_b32 v71, 0
v_mov_b32 v75, 0
v_mov_b32 v79, 0
v_mov_b32 v83, 0
v_mov_b32 v87, 0
v_mov_b32 v91, 0
v_mov_b32 v95, 0
s_nop 1
L_v_wh:
s_mov_b64 exec, s[46:47]
ds_read_b32 v13, v7 offset:12
ds_read_b32 v30, v15 offset:96
s_add_u32 s69, s69, 1
s_waitcnt lgkmcnt(0)
v_readfirstlane_b32 s7, v13
s_mov_b64 exec, -1
s_cmp_gt_u32 s69, 262144
s_nop 2
s_cbranch_scc1 L_end
s_cmp_eq_u32 s7, 0
s_cbranch_scc1 L_v_wh
s_waitcnt vmcnt(3)
L_v_mid:
v_perm_b32 v64, v196, v192, s16
v_perm_b32 v68, v196, v192, s18
v_perm_b32 v72, v197, v193, s16
v_perm_b32 v76, v197, v193, s18
v_perm_b32 v80, v198, v194, s16
v_perm_b32 v84, v198, v194, s18
v_perm_b32 v88, v199, v195, s16
v_perm_b32 v92, v199, v195, s18
v_perm_b32 v65, v204, v200, s16
v_perm_b32 v69, v204, v200, s18
v_perm_b32 v73, v205, v201, s16
v_perm_b32 v77, v205, v201, s18
v_perm_b32 v81, v206, v202, s16
v_perm_b32 v85, v206, v202, s18
v_perm_b32 v89, v207, v203, s16
v_perm_b32 v93, v207, v203, s18
v_perm_b32 v66, v212, v208, s16
v_perm_b32 v70, v212, v208, s18
v_perm_b32 v74, v213, v209, s16
v_perm_b32 v78, v213, v209, s18
v_perm_b32 v82, v214, v210, s16
v_perm_b32 v86, v214, v210, s18
v_perm_b32 v90, v215, v211, s16
v_perm_b32 v94, v215, v211, s18
s_nop 1
L_v_p1d:
s_waitcnt vmcnt(2)
v_perm_b32 v140, v129, v128, s19
v_perm_b32 v141, v131, v130, s39
s_waitcnt vmcnt(1)
v_perm_b32 v142, v133, v132, s19
v_perm_b32 v143, v135, v134, s39
v_add3_u32 v140, v140, v141, v142
v_pk_add_f32 v[146:147], v[128:129], v[132:133]
v_pk_add_f32 v[148:149], v[130:131], v[134:135]
s_waitcnt vmcnt(0)
v_perm_b32 v144, v137, v136, s19
v_perm_b32 v145, v139, v138, s39
v_or_b32 v151, v136, v138
v_add3_u32 v143, v143, v144, v145
v_cndmask_b32 v150, v137, v139, s[28:29]
v_add_u32 v140, v140, v143
v_cmp_lt_u32 vcc, 0xffff, v151
v_cmp_ne_u32 s[26:27], s24, v140
v_permlane32_swap_b32 v146, v148
v_permlane32_swap_b32 v147, v149
s_cmp_lg_u64 s[26:27], 0
s_nop 1
s_cbranch_scc1 L_v_p1r
s_cbranch_vccnz L_v_slow
L_v_back:
v_add_f32_dpp v150, v150, v150 quad_perm:[1,0,3,2] row_mask:0xf bank_mask:0xf
v_pk_add_f32 v[146:147], v[146:147], v[148:149]
s_nop 0
v_add_f32_dpp v150, v150, v150 row_ror:4 row_mask:0xf bank_mask:0xf
v_permlane16_swap_b32 v146, v147
s_nop 0
v_add_f32_dpp v150, v150, v150 row_ror:8 row_mask:0xf bank_mask:0xf
v_add_f32 v146, v146, v147
v_mov_b32 v151, v150
s_nop 0
v_add_f32_dpp v146, v146, v146 row_ror:4 row_mask:0xf bank_mask:0xf
v_permlane16_swap_b32 v150, v151
v_add_f32 v150, v150, v151
v_mov_b32 v151, v150
v_add_f32_dpp v146, v146, v146 row_ror:8 row_mask:0xf bank_mask:0xf
s_nop 0
v_permlane32_swap_b32 v150, v151
v_add_f32 v150, v150, v151
v_rcp_f32 v150, v150
v_mov_b32_dpp v147, v146 quad_perm:[1,0,3,2] row_mask:0xf bank_mask:0xf
v_pk_mul_f32 v[146:147], v[146:147], v[150:151] op_sel_hi:[1,0]
v_cvt_pk_bf16_f32 v146, v146, v147
s_nop 1
v_mov_b32_dpp v28, v146 quad_perm:[0,0,0,0] row_mask:0xf bank_mask:0x5
v_mov_b32_dpp v29, v146 quad_perm:[2,2,2,2] row_mask:0xf bank_mask:0x5
s_nop 1
L_v_h1done:
v_mfma_f32_16x16x32_bf16 v[160:163], v[28:31], v[64:67], 0
v_mfma_f32_16x16x32_bf16 v[176:179], v[28:31], v[80:83], 0
v_mfma_f32_16x16x32_bf16 v[164:167], v[28:31], v[68:71], 0
v_mfma_f32_16x16x32_bf16 v[180:183], v[28:31], v[84:87], 0
v_mfma_f32_16x16x32_bf16 v[168:171], v[28:31], v[72:75], 0
v_mfma_f32_16x16x32_bf16 v[184:187], v[28:31], v[88:91], 0
v_mfma_f32_16x16x32_bf16 v[172:175], v[28:31], v[76:79], 0
v_mfma_f32_16x16x32_bf16 v[188:191], v[28:31], v[92:95], 0
s_mov_b64 exec, s[42:43]
ds_write_b64 v15, v[28:29]
s_mov_b64 exec, 1
ds_write_b32 v7, v8 offset:8
s_mov_b64 exec, -1
v_cndmask_b32 v32, v160, v176, s[80:81]
v_cndmask_b32 v33, v164, v180, s[80:81]
v_cndmask_b32 v34, v168, v184, s[80:81]
v_cndmask_b32 v35, v172, v188, s[80:81]
v_perm_b32 v32, v32, v12, s12
v_perm_b32 v33, v33, v12, s13
v_perm_b32 v34, v34, v12, s14
v_perm_b32 v35, v35, v12, s15
s_cmp_lg_u32 s61, 4
s_nop 0
s_cbranch_scc1 L_v_s21
buffer_store_dwordx4 v[32:35], v27, s[8:11], 0 offen sc1
buffer_store_dwordx4 v[32:35], v23, s[8:11], 0 offen
s_nop 1
s_branch L_v_s22
P9:
s_branch L_v_r2
L_v_s21:
buffer_store_dwordx4 v[32:35], v26, s[8:11], 0 offen sc1
s_nop 1
L_v_s22:
s_mov_b64 exec, 1
ds_add_u32 v7, v8 offset:16
s_mov_b64 exec, -1
s_cmp_ge_u32 s2, 56
s_cbranch_scc1 L_v_fin
s_mov_b64 s[0:1], -1
L_v_w2:
ds_read_b32 v13, v7 offset:16
s_add_u32 s69, s69, 1
s_waitcnt lgkmcnt(0)
v_readfirstlane_b32 s7, v13
s_cmp_gt_u32 s69, 262144
s_nop 3
s_cbranch_scc1 L_end
s_cmp_lt_u32 s7, 4
s_cbranch_scc1 L_v_w2
s_sleep 10
L_v_p2:
s_mov_b64 exec, s[0:1]
buffer_load_dwordx4 v[64:67], v122, s[8:11], s48 offen sc1
buffer_load_dwordx4 v[68:71], v122, s[8:11], s49 offen sc1
buffer_load_dwordx4 v[72:75], v122, s[8:11], s50 offen sc1
buffer_load_dwordx4 v[76:79], v122, s[8:11], s51 offen sc1
s_add_u32 s69, s69, 1
s_cmp_gt_u32 s69, 262144
s_cbranch_scc1 L_end
s_waitcnt vmcnt(3)
v_perm_b32 v96, v65, v64, s19
v_perm_b32 v97, v67, v66, s39
v_add_u32 v112, v96, v97
s_waitcnt vmcnt(2)
v_perm_b32 v98, v69, v68, s19
v_perm_b32 v99, v71, v70, s39
v_add3_u32 v112, v112, v98, v99
s_waitcnt vmcnt(1)
v_perm_b32 v100, v73, v72, s19
v_perm_b32 v101, v75, v74, s39
v_add3_u32 v112, v112, v100, v101
s_waitcnt vmcnt(0)
v_perm_b32 v102, v77, v76, s19
v_perm_b32 v103, v79, v78, s39
v_add3_u32 v112, v112, v102, v103
v_cmp_ne_u32 s[0:1], s87, v112
s_nop 0
s_cmp_lg_u64 s[0:1], 0
s_nop 2
s_cbranch_scc1 L_v_p2
s_mov_b64 exec, -1
v_pk_add_f32 v[64:65], v[64:65], v[72:73]
v_pk_add_f32 v[66:67], v[66:67], v[74:75]
v_pk_add_f32 v[68:69], v[68:69], v[76:77]
v_pk_add_f32 v[70:71], v[70:71], v[78:79]
v_pk_add_f32 v[64:65], v[64:65], v[68:69]
v_pk_add_f32 v[66:67], v[66:67], v[70:71]
s_nop 1
v_permlane32_swap_b32 v64, v66
v_permlane32_swap_b32 v65, v67
v_pk_add_f32 v[64:65], v[64:65], v[66:67]
s_nop 1
v_permlane16_swap_b32 v64, v65
v_add_f32 v64, v64, v65
s_nop 1
v_add_f32_dpp v64, v64, v64 row_ror:4 row_mask:0xf bank_mask:0xf
s_nop 1
v_add_f32_dpp v64, v64, v64 row_ror:8 row_mask:0xf bank_mask:0xf
s_mov_b64 exec, s[22:23]
ds_write_b32 v19, v64
s_mov_b64 exec, 1
ds_add_rtn_u32 v13, v7, v8 offset:40
s_mov_b64 exec, -1
ds_read_b128 v[68:71], v18
s_waitcnt lgkmcnt(0)
v_readfirstlane_b32 s7, v13
v_pk_add_f32 v[68:69], v[68:69], v[70:71]
v_add_f32 v64, v68, v69
s_cmp_lg_u32 s7, 3
s_nop 1
s_cbranch_scc1 L_v_fin
v_mov_b32_dpp v68, v64 quad_perm:[2,3,0,1] row_mask:0xf bank_mask:0xf
v_cvt_pk_bf16_f32 v65, v64, v68
v_and_b32 v68, 0xffff0000, v65
v_lshlrev_b32 v64, 16, v65
v_mul_f32 v66, 0xbfb8aa3b, v68
v_exp_f32 v66, v66
s_nop 0
v_add_f32 v66, 1.0, v66
v_rcp_f32 v66, v66
s_nop 0
v_mul_f32 v66, v68, v66
v_cvt_pk_bf16_f32 v67, v66, v66
v_and_b32 v66, 0xffff0000, v67
v_mul_f32 v64, v64, v66
v_cvt_pk_bf16_f32 v67, v64, v64
v_and_b32 v64, 0xffff0000, v67
v_lshlrev_b32 v126, 16, v126
v_add_f32 v64, v64, v126
v_cvt_pk_bf16_f32 v64, v64, v64
buffer_store_short v64, v9, s[32:35], 0 offen
s_cmp_lg_u32 s2, 0
s_cbranch_scc1 L_v_fin
v_lshlrev_b32 v13, 24, v0
buffer_store_dword v12, v13, s[8:11], 0 offen
s_nop 0
L_v_fin:
s_endpgm
L_k:
s_setprio 1
s_lshl_b32 s6, s4, 25
s_add_u32 s6, s6, 0x1e00000
v_and_b32 v4, 7, v2
v_lshlrev_b32 v4, 9, v4
v_lshrrev_b32 v5, 3, v2
v_lshl_add_u32 v4, v5, 6, v4
v_lshl_add_u32 v4, v3, 4, v4
s_lshl_b32 s7, s3, 19
s_lshl_b32 s44, s5, 12
s_add_u32 s7, s7, s44
s_and_b32 s44, s3, 1
s_lshl_b32 s44, s44, 13
s_xor_b32 s7, s7, s44
v_add_u32 v4, s7, v4
v_xor_b32 v6, 0x2000, v4
s_mov_b32 s48, 131072
s_mov_b32 s49, 262144
s_mov_b32 s50, 393216
s_mov_b32 s42, 2097152
s_mov_b32 s43, 0x20000
s_mov_b32 s10, 16777216
s_mov_b32 s11, 0x20000
v_mov_b32 v8, 0
v_mov_b32 v9, 0
v_mov_b32 v10, 0
v_mov_b32 v11, 0
v_lshlrev_b32 v7, 4, v2
v_add_u32 v7, 3072, v7
s_cmp_lg_u32 s3, 0
s_nop 0
s_cbranch_scc1 L_k_noz
ds_write_b128 v7, v[8:11]
L_k_noz:
s_waitcnt lgkmcnt(0)
s_cbranch_scc1 L_k_nsp
s_load_dword s74, s[18:19], s6
s_load_dword s64, s[28:29], 0
s_load_dword s65, s[30:31], 0
L_k_nsp:
s_add_u32 s40, s18, s6
s_addc_u32 s41, s19, 0
s_mov_b32 s8, s38
s_mov_b32 s9, s39
s_load_dword s6, s[38:39], 0
s_barrier
s_cmp_lg_u32 s3, 2
s_cbranch_scc1 L_k_nsq
s_lshl_b32 s64, s4, 25
s_add_u32 s64, s64, 0x1e00000
s_load_dword s66, s[20:21], s64
s_mul_i32 s62, s4, 458752
s_add_u32 s63, s62, 458748
s_load_dword s67, s[24:25], s62
s_load_dword s68, s[24:25], s63
s_load_dword s69, s[32:33], 0
s_mov_b32 s65, 0x200000
s_load_dword s70, s[38:39], s65
s_load_dword s71, s[34:35], 0
L_k_nsq:
s_branch P5_o
.p2align 12
P5:
s_branch L_k
P5_o:
s_mov_b32 s58, 0x0c0c0400
s_mov_b32 s59, 0x04000c0c
s_lshl_b32 s16, s4, 5
s_add_u32 s16, s16, s5
s_mul_i32 s61, s4, 28
s_min_u32 s7, s5, 27
s_add_u32 s61, s61, s7
v_lshrrev_b32 v16, 1, v3
v_and_b32 v17, 1, v3
v_bfe_u32 v18, v2, 2, 1
v_mov_b32 v11, 2147483632
v_and_b32 v14, 1, v2
v_lshlrev_b32 v13, 9, v14
v_bfe_u32 v15, v2, 1, 1
v_lshl_add_u32 v13, v15, 6, v13
v_lshl_add_u32 v13, v3, 4, v13
v_lshlrev_b32 v15, 10, v16
v_lshl_add_u32 v15, v14, 9, v15
v_lshl_add_u32 v15, v17, 7, v15
s_mul_i32 s7, s3, 0x90
s_and_b32 s7, s7, 0x110
s_add_u32 s7, s7, 1024
v_add_u32 v15, s7, v15
v_lshrrev_b32 v17, 1, v2
v_cmp_eq_u32 s[60:61], v17, v16
v_lshlrev_b32 v18, 9, v18
v_lshl_add_u32 v18, v14, 7, v18
v_lshl_add_u32 v18, v3, 5, v18
v_add_u32 v18, 1024, v18
s_lshl_b32 s7, s4, 13
s_lshl_b32 s44, s3, 11
s_add_u32 s7, s7, s44
s_add_u32 s7, s7, 524288
v_lshlrev_b32 v23, 4, v0
v_add_u32 v19, s7, v23
s_lshl_b32 s7, s3, 8
v_lshlrev_b32 v20, 3, v2
v_lshl_add_u32 v20, v16, 7, v20
v_and_b32 v17, 1, v3
v_lshl_add_u32 v20, v17, 2, v20
v_add_u32 v20, s7, v20
s_getreg_b32 s17, hwreg(HW_REG_XCC_ID, 0, 3)
v_add_u32 v23, 4096, v23
s_lshl_b32 s7, s16, 12
s_add_u32 s7, s7, 1048576
v_and_b32 v14, 1, v0
v_lshrrev_b32 v17, 1, v0
v_mul_u32_u24 v17, 64, v17
v_add_u32 v17, s7, v17
v_lshl_add_u32 v16, v14, 5, v17
v_mov_b32 v24, 3200
v_mov_b32 v25, 1
s_mov_b32 s23, 0
s_mul_i32 s56, s3, 15
s_add_u32 s56, s56, s52
s_add_u32 s56, s56, 105
s_mul_i32 s7, s3, 4
s_sub_u32 s56, s56, s7
s_add_u32 s56, s56, 0
L_kp0:
s_memrealtime s[54:55]
s_waitcnt lgkmcnt(0)
s_sub_u32 s54, s54, s56
s_cmp_lt_i32 s54, 0
s_cbranch_scc1 L_kp0
buffer_load_dwordx4 v[64:67], v4, s[40:43], 0 offen offset:0 nt
buffer_load_dwordx4 v[68:71], v4, s[40:43], 0 offen offset:128 nt
buffer_load_dwordx4 v[72:75], v4, s[40:43], 0 offen offset:256 nt
buffer_load_dwordx4 v[76:79], v4, s[40:43], 0 offen offset:384 nt
s_mul_i32 s7, s3, 4
s_add_u32 s56, s56, s7
s_sub_u32 s56, s56, 0
s_add_u32 s56, s56, 60
L_kp1:
s_memrealtime s[54:55]
s_waitcnt lgkmcnt(0)
s_sub_u32 s54, s54, s56
s_cmp_lt_i32 s54, 0
s_cbranch_scc1 L_kp1
buffer_load_dwordx4 v[80:83], v6, s[40:43], s48 offen offset:0 nt
buffer_load_dwordx4 v[84:87], v6, s[40:43], s48 offen offset:128 nt
buffer_load_dwordx4 v[88:91], v6, s[40:43], s48 offen offset:256 nt
buffer_load_dwordx4 v[92:95], v6, s[40:43], s48 offen offset:384 nt
s_add_u32 s56, s56, 60
L_kp2:
s_memrealtime s[54:55]
s_waitcnt lgkmcnt(0)
s_sub_u32 s54, s54, s56
s_cmp_lt_i32 s54, 0
s_cbranch_scc1 L_kp2
buffer_load_dwordx4 v[96:99], v4, s[40:43], s49 offen offset:0 nt
buffer_load_dwordx4 v[100:103], v4, s[40:43], s49 offen offset:128 nt
buffer_load_dwordx4 v[104:107], v4, s[40:43], s49 offen offset:256 nt
buffer_load_dwordx4 v[108:111], v4, s[40:43], s49 offen offset:384 nt
s_add_u32 s57, s52, 250
L_k_gt3:
s_memrealtime s[54:55]
s_waitcnt lgkmcnt(0)
s_sub_u32 s54, s54, s57
s_cmp_lt_i32 s54, 0
s_cbranch_scc1 L_k_gt3
buffer_load_dwordx4 v[32:35], v19, s[8:11], 0 offen sc1
buffer_load_dwordx4 v[36:39], v19, s[8:11], 0 offen offset:1024 sc1
s_add_u32 s56, s56, 60
L_kp3:
s_memrealtime s[54:55]
s_waitcnt lgkmcnt(0)
s_sub_u32 s54, s54, s56
s_cmp_lt_i32 s54, 0
s_cbranch_scc1 L_kp3
buffer_load_dwordx4 v[112:115], v6, s[40:43], s50 offen offset:0 nt
buffer_load_dwordx4 v[116:119], v6, s[40:43], s50 offen offset:128 nt
buffer_load_dwordx4 v[120:123], v6, s[40:43], s50 offen offset:256 nt
buffer_load_dwordx4 v[124:127], v6, s[40:43], s50 offen offset:384 nt
s_waitcnt lgkmcnt(0)
s_mul_i32 s6, s6, 1664525
s_add_u32 s6, s6, 1013904223
s_or_b32 s6, s6, 1
v_mov_b32 v12, s6
v_and_b32 v14, 3, v0
v_lshlrev_b32 v14, 3, v14
v_bfe_u32 v5, v12, v14, 8
s_lshl_b32 s17, s17, 29
s_and_b32 s7, s6, 0x1fffffff
s_or_b32 s17, s17, s7
v_mov_b32 v45, 0x1fffffff
s_mov_b64 exec, 1
ds_add_u32 v24, v25 offset:28
s_mov_b64 exec, -1
s_waitcnt vmcnt(4)
s_branch L_k_qc
L_k_q:
s_and_b32 s7, s23, 1
s_cmp_eq_u32 s7, 1
s_cselect_b32 s7, 65536, 0
s_mov_b64 exec, s[0:1]
buffer_load_dwordx4 v[32:35], v19, s[8:11], s7 offen sc1
buffer_load_dwordx4 v[36:39], v19, s[8:11], s7 offen offset:1024 sc1
s_mov_b64 exec, -1
s_add_u32 s23, s23, 1
s_cmp_gt_u32 s23, 262144
s_cbranch_scc1 L_end
s_waitcnt vmcnt(0)
L_k_qc:
v_perm_b32 v40, v33, v32, s58
v_perm_b32 v41, v35, v34, s59
v_perm_b32 v42, v37, v36, s58
v_perm_b32 v43, v39, v38, s59
v_xor_b32 v40, v40, v41
v_xor_b32 v42, v42, v43
v_xor_b32 v40, s17, v40
v_xor_b32 v42, s17, v42
v_or_b32 v40, v40, v42
v_and_b32 v41, v45, v40
v_cmp_ne_u32 s[0:1], 0, v41
v_cmp_ne_u32 vcc, 0, v40
s_cmp_lg_u64 s[0:1], 0
s_nop 3
s_cbranch_scc1 L_k_q
s_cbranch_vccnz L_k_mix
s_mov_b64 exec, 1
ds_add_u32 v24, v25 offset:4
s_mov_b64 exec, -1
L_k_mix:
v_and_b32 v32, 0xffffff00, v32
v_and_b32 v33, 0xffffff00, v33
v_and_b32 v34, 0xffffff00, v34
v_and_b32 v35, 0xffffff00, v35
v_and_b32 v36, 0xffffff00, v36
v_and_b32 v37, 0xffffff00, v37
v_and_b32 v38, 0xffffff00, v38
v_and_b32 v39, 0xffffff00, v39
v_permlane32_swap_b32 v32, v36
v_permlane32_swap_b32 v33, v37
v_permlane32_swap_b32 v34, v38
v_permlane32_swap_b32 v35, v39
v_pk_add_f32 v[32:33], v[32:33], v[36:37]
v_pk_add_f32 v[34:35], v[34:35], v[38:39]
s_nop 1
v_permlane16_swap_b32 v32, v34
v_permlane16_swap_b32 v33, v35
v_pk_add_f32 v[32:33], v[32:33], v[34:35]
v_cvt_pk_bf16_f32 v32, v32, v33
ds_write_b32 v20, v32
s_mov_b64 exec, 1
ds_add_u32 v24, v25 offset:32
s_mov_b64 exec, -1
s_branch P6_o
P6:
s_branch L_k
P6_o:
L_k_wq:
ds_read_b32 v28, v24 offset:32
s_add_u32 s23, s23, 1
s_waitcnt lgkmcnt(0)
v_readfirstlane_b32 s7, v28
s_cmp_gt_u32 s23, 262144
s_nop 3
s_cbranch_scc1 L_end
s_cmp_lt_u32 s7, 4
s_cbranch_scc1 L_k_wq
ds_read_b128 v[32:35], v13 offset:0
ds_read_b128 v[36:39], v13 offset:128
ds_read_b128 v[40:43], v13 offset:256
ds_read_b128 v[44:47], v13 offset:384
s_waitcnt lgkmcnt(0)
v_mfma_f32_16x16x32_bf16 v[48:51], v[64:67], v[32:35], 0
v_mfma_f32_16x16x32_bf16 v[52:55], v[80:83], v[32:35], 0
v_mfma_f32_16x16x32_bf16 v[56:59], v[96:99], v[32:35], 0
v_mfma_f32_16x16x32_bf16 v[48:51], v[68:71], v[36:39], v[48:51]
v_mfma_f32_16x16x32_bf16 v[52:55], v[84:87], v[36:39], v[52:55]
v_mfma_f32_16x16x32_bf16 v[56:59], v[100:103], v[36:39], v[56:59]
v_mfma_f32_16x16x32_bf16 v[48:51], v[72:75], v[40:43], v[48:51]
v_mfma_f32_16x16x32_bf16 v[52:55], v[88:91], v[40:43], v[52:55]
v_mfma_f32_16x16x32_bf16 v[56:59], v[104:107], v[40:43], v[56:59]
v_mfma_f32_16x16x32_bf16 v[48:51], v[76:79], v[44:47], v[48:51]
v_mfma_f32_16x16x32_bf16 v[52:55], v[92:95], v[44:47], v[52:55]
v_mfma_f32_16x16x32_bf16 v[56:59], v[108:111], v[44:47], v[56:59]
s_mov_b64 exec, s[60:61]
s_nop 4
ds_write2_b32 v15, v48, v49 offset0:0 offset1:8
ds_write2_b32 v15, v50, v51 offset0:16 offset1:24
ds_write2_b32 v15, v52, v53 offset0:1 offset1:9
ds_write2_b32 v15, v54, v55 offset0:17 offset1:25
ds_write2_b32 v15, v56, v57 offset0:2 offset1:10
ds_write2_b32 v15, v58, v59 offset0:18 offset1:26
s_mov_b64 exec, -1
s_waitcnt vmcnt(3)
v_mfma_f32_16x16x32_bf16 v[60:63], v[112:115], v[32:35], 0
s_waitcnt vmcnt(2)
v_mfma_f32_16x16x32_bf16 v[60:63], v[116:119], v[36:39], v[60:63]
s_waitcnt vmcnt(1)
v_mfma_f32_16x16x32_bf16 v[60:63], v[120:123], v[40:43], v[60:63]
s_waitcnt vmcnt(0)
v_mfma_f32_16x16x32_bf16 v[60:63], v[124:127], v[44:47], v[60:63]
s_mov_b64 exec, s[60:61]
s_nop 6
ds_write2_b32 v15, v60, v61 offset0:3 offset1:11
ds_write2_b32 v15, v62, v63 offset0:19 offset1:27
s_mov_b64 exec, 1
ds_add_u32 v24, v25
s_mov_b64 exec, -1
s_mov_b32 s62, 0x3db8aa3b
s_cmp_lg_u32 s3, 1
s_cbranch_scc1 L_k_nsm
s_mov_b32 s63, 0x44200000
L_k_w1:
ds_read_b32 v28, v24
s_add_u32 s23, s23, 1
s_waitcnt lgkmcnt(0)
v_readfirstlane_b32 s7, v28
s_cmp_gt_u32 s23, 262144
s_nop 3
s_cbranch_scc1 L_end
s_cmp_lt_u32 s7, 4
s_cbranch_scc1 L_k_w1
ds_read_b128 v[64:67], v18 offset:0
ds_read_b128 v[68:71], v18 offset:16
ds_read_b128 v[72:75], v18 offset:256
ds_read_b128 v[76:79], v18 offset:272
ds_read_b128 v[80:83], v18 offset:1024
ds_read_b128 v[84:87], v18 offset:1040
ds_read_b128 v[88:91], v18 offset:1280
ds_read_b128 v[92:95], v18 offset:1296
s_waitcnt lgkmcnt(0)
v_pk_add_f32 v[64:65], v[64:65], v[80:81]
v_pk_add_f32 v[66:67], v[66:67], v[82:83]
v_pk_add_f32 v[68:69], v[68:69], v[84:85]
v_pk_add_f32 v[70:71], v[70:71], v[86:87]
v_pk_add_f32 v[72:73], v[72:73], v[88:89]
v_pk_add_f32 v[74:75], v[74:75], v[90:91]
v_pk_add_f32 v[76:77], v[76:77], v[92:93]
v_pk_add_f32 v[78:79], v[78:79], v[94:95]
v_cvt_pk_bf16_f32 v80, v64, v65
v_cvt_pk_bf16_f32 v81, v66, v67
v_cvt_pk_bf16_f32 v82, v68, v69
v_cvt_pk_bf16_f32 v83, v70, v71
v_cvt_pk_bf16_f32 v84, v72, v73
v_cvt_pk_bf16_f32 v85, v74, v75
v_cvt_pk_bf16_f32 v86, v76, v77
v_cvt_pk_bf16_f32 v87, v78, v79
v_lshlrev_b32 v64, 16, v80
v_and_b32 v65, 0xffff0000, v80
v_lshlrev_b32 v66, 16, v81
v_and_b32 v67, 0xffff0000, v81
v_lshlrev_b32 v68, 16, v82
v_and_b32 v69, 0xffff0000, v82
v_lshlrev_b32 v70, 16, v83
v_and_b32 v71, 0xffff0000, v83
v_lshlrev_b32 v72, 16, v84
v_and_b32 v73, 0xffff0000, v84
v_lshlrev_b32 v74, 16, v85
v_and_b32 v75, 0xffff0000, v85
v_lshlrev_b32 v76, 16, v86
v_and_b32 v77, 0xffff0000, v86
v_lshlrev_b32 v78, 16, v87
v_and_b32 v79, 0xffff0000, v87
v_max3_f32 v96, v64, v65, v66
v_max3_f32 v97, v67, v68, v69
v_max3_f32 v98, v70, v71, v72
v_max3_f32 v99, v73, v74, v75
v_max3_f32 v96, v96, v76, v77
v_max3_f32 v97, v97, v78, v79
v_max3_f32 v96, v96, v97, v98
v_max_f32 v96, v96, v99
s_nop 1
v_max_f32_dpp v96, v96, v96 quad_perm:[1,0,3,2] row_mask:0xf bank_mask:0xf
v_mov_b32 v97, v96
s_nop 1
v_permlane16_swap_b32 v96, v97
v_max_f32 v96, v96, v97
v_mov_b32 v97, v96
s_nop 1
v_permlane32_swap_b32 v96, v97
v_max_f32 v96, v96, v97
v_cmp_gt_f32 vcc, s63, |v96|
s_nop 1
v_cndmask_b32 v96, v96, 0, vcc
v_mul_f32 v97, s62, v96
v_fma_f32 v64, v64, s62, -v97
v_fma_f32 v65, v65, s62, -v97
v_fma_f32 v66, v66, s62, -v97
v_fma_f32 v67, v67, s62, -v97
v_fma_f32 v68, v68, s62, -v97
v_fma_f32 v69, v69, s62, -v97
v_fma_f32 v70, v70, s62, -v97
v_fma_f32 v71, v71, s62, -v97
v_fma_f32 v72, v72, s62, -v97
v_fma_f32 v73, v73, s62, -v97
v_fma_f32 v74, v74, s62, -v97
v_fma_f32 v75, v75, s62, -v97
v_fma_f32 v76, v76, s62, -v97
v_fma_f32 v77, v77, s62, -v97
v_fma_f32 v78, v78, s62, -v97
v_fma_f32 v79, v79, s62, -v97
v_exp_f32 v64, v64
v_exp_f32 v65, v65
v_exp_f32 v66, v66
v_exp_f32 v67, v67
v_exp_f32 v68, v68
v_exp_f32 v69, v69
v_exp_f32 v70, v70
v_exp_f32 v71, v71
v_exp_f32 v72, v72
v_exp_f32 v73, v73
v_exp_f32 v74, v74
v_exp_f32 v75, v75
v_exp_f32 v76, v76
v_exp_f32 v77, v77
v_exp_f32 v78, v78
v_exp_f32 v79, v79
v_cvt_pk_bf16_f32 v100, v64, v65
v_cvt_pk_bf16_f32 v101, v66, v67
v_cvt_pk_bf16_f32 v102, v68, v69
v_cvt_pk_bf16_f32 v103, v70, v71
v_cvt_pk_bf16_f32 v104, v72, v73
v_cvt_pk_bf16_f32 v105, v74, v75
v_cvt_pk_bf16_f32 v106, v76, v77
v_cvt_pk_bf16_f32 v107, v78, v79
ds_write_b128 v23, v[100:103]
ds_write_b128 v23, v[104:107] offset:1024
v_pk_add_f32 v[64:65], v[64:65], v[72:73]
v_pk_add_f32 v[66:67], v[66:67], v[74:75]
v_pk_add_f32 v[68:69], v[68:69], v[76:77]
v_pk_add_f32 v[70:71], v[70:71], v[78:79]
v_pk_add_f32 v[64:65], v[64:65], v[68:69]
v_pk_add_f32 v[66:67], v[66:67], v[70:71]
v_pk_add_f32 v[64:65], v[64:65], v[66:67]
v_add_f32 v98, v64, v65
s_nop 1
v_add_f32_dpp v98, v98, v98 quad_perm:[1,0,3,2] row_mask:0xf bank_mask:0xf
v_mov_b32 v97, v98
s_nop 1
v_permlane16_swap_b32 v98, v97
v_add_f32 v98, v98, v97
v_mov_b32 v97, v98
s_nop 1
v_permlane32_swap_b32 v98, v97
v_add_f32 v98, v98, v97
v_mov_b32_dpp v108, v96 row_newbcast:0 row_mask:0xf bank_mask:0xf
s_nop 0
v_mov_b32_dpp v109, v98 row_newbcast:0 row_mask:0xf bank_mask:0xf
v_mov_b32_dpp v110, v96 row_newbcast:4 row_mask:0xf bank_mask:0xf
v_mov_b32_dpp v111, v98 row_newbcast:4 row_mask:0xf bank_mask:0xf
ds_write_b128 v23, v[108:111] offset:2048
ds_write_b32 v24, v25 offset:36
L_k_nsm:
s_branch P7_o
P7:
s_branch L_k
P7_o:
s_cmp_eq_u32 s3, 0
s_cselect_b32 s7, 0, 30
s_add_u32 s52, s52, s7
s_cmp_eq_u32 s3, 2
s_cbranch_scc1 L_k_par
s_sub_u32 s7, s3, 1
s_cmp_lt_u32 s7, 2
s_cbranch_scc1 L_k_fin
s_branch L_k_wvi_e
L_k_wvi:
s_sleep 1
L_k_wvi_e:
ds_read_b32 v28, v24 offset:24
s_add_u32 s23, s23, 1
s_waitcnt lgkmcnt(0)
v_readfirstlane_b32 s7, v28
s_cmp_gt_u32 s23, 262144
s_nop 3
s_cbranch_scc1 L_end
s_cmp_lt_u32 s7, 4
s_cbranch_scc1 L_k_wvi
s_add_u32 s52, s52, 588
L_k_wt:
s_memrealtime s[54:55]
s_waitcnt lgkmcnt(0)
s_sub_u32 s54, s54, s52
s_cmp_gt_u32 s54, 0x80000000
s_cbranch_scc1 L_k_wt
s_setprio 3
s_cmp_eq_u32 s3, 0
s_cbranch_scc1 L_k_ffn
s_cmp_lg_u32 s3, 3
s_cbranch_scc1 L_k_perm
buffer_load_dwordx4 v[160:163], v16, s[8:11], 0 offen nt
s_mov_b64 exec, 0xffff
buffer_load_dwordx4 v[164:167], v17, s[8:11], 0 offen offset:2048 nt
s_mov_b64 exec, -1
s_branch L_k_perm
L_k_ffn:
v_mov_b32 v32, 0
s_cmp_gt_u32 s5, 27
s_nop 0
s_cbranch_scc1 L_k_hw
s_mul_i32 s7, s4, 28
s_add_u32 s7, s7, s5
s_lshl_b32 s7, s7, 8
s_add_u32 s7, s7, 131072
s_add_u32 s18, s8, s7
s_addc_u32 s19, s9, 0
L_k_gf:
s_load_dwordx16 s[24:39], s[18:19], 0 glc
s_load_dwordx16 s[40:55], s[18:19], 64 glc
s_load_dwordx16 s[56:71], s[18:19], 128 glc
s_load_dwordx16 s[72:87], s[18:19], 192 glc
s_add_u32 s23, s23, 1
s_cmp_gt_u32 s23, 262144
s_cbranch_scc1 L_end
s_waitcnt lgkmcnt(0)
v_writelane_b32 v13, s24, 0
v_writelane_b32 v13, s25, 1
v_writelane_b32 v13, s26, 2
v_writelane_b32 v13, s27, 3
v_writelane_b32 v13, s28, 4
v_writelane_b32 v13, s29, 5
v_writelane_b32 v13, s30, 6
v_writelane_b32 v13, s31, 7
v_writelane_b32 v13, s32, 8
v_writelane_b32 v13, s33, 9
v_writelane_b32 v13, s34, 10
v_writelane_b32 v13, s35, 11
v_writelane_b32 v13, s36, 12
v_writelane_b32 v13, s37, 13
v_writelane_b32 v13, s38, 14
v_writelane_b32 v13, s39, 15
v_writelane_b32 v13, s40, 16
v_writelane_b32 v13, s41, 17
v_writelane_b32 v13, s42, 18
v_writelane_b32 v13, s43, 19
v_writelane_b32 v13, s44, 20
v_writelane_b32 v13, s45, 21
v_writelane_b32 v13, s46, 22
v_writelane_b32 v13, s47, 23
v_writelane_b32 v13, s48, 24
v_writelane_b32 v13, s49, 25
v_writelane_b32 v13, s50, 26
v_writelane_b32 v13, s51, 27
v_writelane_b32 v13, s52, 28
v_writelane_b32 v13, s53, 29
v_writelane_b32 v13, s54, 30
v_writelane_b32 v13, s55, 31
v_writelane_b32 v13, s56, 32
v_writelane_b32 v13, s57, 33
v_writelane_b32 v13, s58, 34
v_writelane_b32 v13, s59, 35
v_writelane_b32 v13, s60, 36
v_writelane_b32 v13, s61, 37
v_writelane_b32 v13, s62, 38
v_writelane_b32 v13, s63, 39
v_writelane_b32 v13, s64, 40
v_writelane_b32 v13, s65, 41
v_writelane_b32 v13, s66, 42
v_writelane_b32 v13, s67, 43
v_writelane_b32 v13, s68, 44
v_writelane_b32 v13, s69, 45
v_writelane_b32 v13, s70, 46
v_writelane_b32 v13, s71, 47
v_writelane_b32 v13, s72, 48
v_writelane_b32 v13, s73, 49
v_writelane_b32 v13, s74, 50
v_writelane_b32 v13, s75, 51
v_writelane_b32 v13, s76, 52
v_writelane_b32 v13, s77, 53
v_writelane_b32 v13, s78, 54
v_writelane_b32 v13, s79, 55
v_writelane_b32 v13, s80, 56
v_writelane_b32 v13, s81, 57
v_writelane_b32 v13, s82, 58
v_writelane_b32 v13, s83, 59
v_writelane_b32 v13, s84, 60
v_writelane_b32 v13, s85, 61
v_writelane_b32 v13, s86, 62
v_writelane_b32 v13, s87, 63
v_and_b32 v14, 0xff, v13
v_cmp_ne_u32 vcc, v14, v5
s_nop 4
s_cbranch_vccnz L_k_gf
v_and_b32 v13, 0xffffff00, v13
s_nop 1
v_add_f32_dpp v13, v13, v13 row_ror:8 row_mask:0xf bank_mask:0xf
v_mov_b32 v14, v13
s_nop 1
v_permlane16_swap_b32 v13, v14
v_add_f32 v13, v13, v14
v_mov_b32 v14, v13
s_nop 1
v_permlane32_swap_b32 v13, v14
v_cvt_pk_bf16_f32 v34, v13, v14
v_lshlrev_b32 v32, 16, v34
v_and_b32 v33, 0xffff0000, v34
v_mul_f32 v34, 0xbfb8aa3b, v32
v_exp_f32 v34, v34
s_nop 0
v_add_f32 v34, 1.0, v34
v_rcp_f32 v34, v34
s_nop 0
v_mul_f32 v32, v32, v34
v_cvt_pk_bf16_f32 v34, v32, v32
v_and_b32 v32, 0xffff0000, v34
v_mul_f32 v32, v32, v33
s_nop 1
v_mov_b32_dpp v33, v32 quad_perm:[1,1,3,3] row_mask:0xf bank_mask:0xf
v_cvt_pk_bf16_f32 v32, v32, v33
s_nop 1
L_k_hw:
s_branch P8_o
P8:
s_branch P9
P8_o:
v_lshlrev_b32 v33, 2, v0
v_add_u32 v33, 3168, v33
s_mov_b64 exec, 0x55
ds_write_b32 v33, v32
s_mov_b64 exec, 1
ds_write_b32 v24, v25 offset:12
s_mov_b64 exec, -1
L_k_perm:
s_waitcnt vmcnt(0)
L_k_fin:
L_end:
s_endpgm
L_v_slow:
v_cndmask_b32 v140, v136, v138, s[28:29]
v_and_b32 v140, 0xffff0000, v140
s_nop 1
v_max_f32_dpp v141, v140, v140 quad_perm:[1,0,3,2] row_mask:0xf bank_mask:0xf
s_nop 1
v_max_f32_dpp v141, v141, v141 row_ror:4 row_mask:0xf bank_mask:0xf
s_nop 1
v_max_f32_dpp v141, v141, v141 row_ror:8 row_mask:0xf bank_mask:0xf
v_mov_b32 v151, v141
s_nop 1
v_permlane16_swap_b32 v141, v151
v_max_f32 v141, v141, v151
v_mov_b32 v151, v141
s_nop 1
v_permlane32_swap_b32 v141, v151
v_max_f32 v141, v141, v151
v_sub_f32 v140, v140, v141
v_mul_f32 v140, 0x3db8aa3b, v140
v_exp_f32 v140, v140
s_nop 0
v_mul_f32 v150, v150, v140
v_bfe_u32 v141, v0, 2, 1
v_and_b32 v142, 2, v0
v_or_b32 v141, v141, v142
v_lshrrev_b32 v142, 3, v0
v_lshl_add_u32 v141, v142, 2, v141
v_lshlrev_b32 v141, 2, v141
ds_bpermute_b32 v152, v141, v140
ds_bpermute_b32 v153, v141, v140 offset:128
s_waitcnt lgkmcnt(0)
v_mul_f32 v128, v128, v152
v_mul_f32 v129, v129, v152
v_mul_f32 v130, v130, v152
v_mul_f32 v131, v131, v152
v_mul_f32 v132, v132, v153
v_mul_f32 v133, v133, v153
v_mul_f32 v134, v134, v153
v_mul_f32 v135, v135, v153
v_pk_add_f32 v[146:147], v[128:129], v[132:133]
v_pk_add_f32 v[148:149], v[130:131], v[134:135]
s_nop 1
v_permlane32_swap_b32 v146, v148
v_permlane32_swap_b32 v147, v149
s_nop 1
s_branch L_v_back
L_k_par:
s_and_b32 s7, s2, 63
s_lshl_b32 s7, s7, 8
s_add_u32 s7, s7, 327680
s_add_u32 s18, s8, s7
s_addc_u32 s19, s9, 0
s_branch L_k_pe
L_k_pl:
s_sleep 8
s_add_u32 s23, s23, 1
s_cmp_gt_u32 s23, 262144
s_cbranch_scc1 L_end
L_k_pe:
s_load_dwordx8 s[24:31], s[18:19], 0 glc
s_and_b32 s36, s6, -8
s_mov_b32 s37, s36
s_waitcnt lgkmcnt(0)
s_xor_b64 s[24:25], s[24:25], s[36:37]
s_xor_b64 s[26:27], s[26:27], s[36:37]
s_xor_b64 s[28:29], s[28:29], s[36:37]
s_xor_b64 s[30:31], s[30:31], s[36:37]
s_or_b64 s[36:37], s[24:25], s[26:27]
s_or_b64 s[36:37], s[36:37], s[28:29]
s_or_b64 s[36:37], s[36:37], s[30:31]
s_or_b32 s7, s36, s37
s_cmp_gt_u32 s7, 7
s_cbranch_scc1 L_k_pl
s_add_u32 s24, s24, s25
s_add_u32 s26, s26, s27
s_add_u32 s28, s28, s29
s_add_u32 s30, s30, s31
s_add_u32 s24, s24, s26
s_add_u32 s28, s28, s30
s_add_u32 s24, s24, s28
s_cmp_gt_u32 s24, 24
s_cselect_b32 s7, 8193, 1
v_mov_b32 v28, s7
s_mov_b64 exec, 1
ds_write_b32 v24, v28 offset:52
s_mov_b64 exec, -1
s_branch L_k_fin
L_dec:
s_getreg_b32 s7, hwreg(HW_REG_XCC_ID, 2, 1)
s_lshl_b32 s7, s7, 13
s_add_u32 s7, s7, 3014656
s_add_u32 s44, s38, s7
s_addc_u32 s45, s39, 0
s_xor_b32 s7, s7, 0x2000
s_add_u32 s48, s38, s7
s_addc_u32 s49, s39, 0
s_mov_b32 s46, 3
L_dec_l:
s_not_b32 s7, s51
s_mov_b32 s51, s7
s_load_dword s50, s[44:45], 0 glc
s_load_dword s51, s[48:49], 0 glc
s_waitcnt lgkmcnt(1)
s_sleep 1
s_cmp_eq_u32 s51, s7
s_subb_u32 s46, s46, 0
s_waitcnt lgkmcnt(0)
s_not_b32 s7, s51
s_mov_b32 s51, s7
s_load_dword s50, s[48:49], 0 glc
s_load_dword s51, s[44:45], 0 glc
s_waitcnt lgkmcnt(1)
s_sleep 1
s_cmp_eq_u32 s51, s7
s_addc_u32 s46, s46, 0
L_dec_d:
s_mul_i32 s7, s6, 1664525
s_add_u32 s7, s7, 1013904223
s_and_b32 s7, s7, -8
s_or_b32 s7, s7, s46
s_lshl_b32 s0, s4, 2
s_add_u32 s0, s0, 327680
v_mov_b32 v13, s7
v_lshlrev_b32 v14, 8, v0
v_add_u32 v14, s0, v14
global_store_dword v14, v13, s[38:39] sc1
s_waitcnt lgkmcnt(0)
s_branch P8
.section .rodata,"a"
.p2align 6
.amdhsa_kernel recurrent_scan__sliding_block_cached__swiglu_ffn__decode_kernel
  .amdhsa_next_free_vgpr 224
  .amdhsa_next_free_sgpr 102
  .amdhsa_accum_offset 224
  .amdhsa_group_segment_fixed_size 0
  .amdhsa_kernarg_size 96
  .amdhsa_user_sgpr_count 2
  .amdhsa_user_sgpr_kernarg_segment_ptr 1
  .amdhsa_system_sgpr_workgroup_id_x 1
.end_amdhsa_kernel
```
